```python
import torch

def _softmax(x, axis=-1):
    return torch.softmax(x, dim=axis)
def _gelu(x):
    return torch.nn.functional.gelu(x, approximate="tanh")
def _silu(x):
    return torch.nn.functional.silu(x)
def _sigmoid(x):
    return torch.sigmoid(x)
def _layernorm(x, axis=-1, eps=1e-5):
    m = x.mean(dim=axis, keepdim=True)
    v = x.var(dim=axis, keepdim=True, unbiased=False)
    return (x - m) / torch.sqrt(v + eps)
def _scatter_add(tgt, idx, src, axis=0):
    return tgt.clone().index_add_(axis, idx, src)
def _segment_sum(src, seg, n):
    out = torch.zeros((n,) + src.shape[1:], dtype=src.dtype)
    return out.index_add_(0, seg, src)
def _pad(x, pw):
    flat = tuple(v for pair in reversed(pw) for v in pair)
    return torch.nn.functional.pad(x, flat)

kernel_name = 'parallel_sum__sliding_block__glu_gated_reglu__prompt'

def setup_inputs():

    _w = (lambda a: (lambda t: t.to(torch.bfloat16) if t.is_floating_point() else t)(torch.as_tensor(a)))
    def _A_setup():
        B, S, D = 1, 2048, 512
        return {
            "x": _w((lambda *s: torch.randn(*s, dtype=torch.bfloat16) * 0.05)(B, S, D)),
            "wqkv": _w((lambda *s: torch.randn(*s, dtype=torch.bfloat16) * 0.05)(D, 3 * D)),
            "wo": _w((lambda *s: torch.randn(*s, dtype=torch.bfloat16) * 0.05)(D, D)),
        }
    _A_in = _A_setup()

    def _B_setup():
        B, S, D, F = 1, 2048, 512, 1376
        return {
            "x": _w((lambda *s: torch.randn(*s, dtype=torch.bfloat16) * 0.05)(B, S, D)),
            "W_gate": _w((lambda *s: torch.randn(*s, dtype=torch.bfloat16) * 0.8)(D, F) * (2.0 / D) ** 0.5),
            "W_up": _w((lambda *s: torch.randn(*s, dtype=torch.bfloat16) * 0.8)(D, F) * (2.0 / D) ** 0.5),
            "W_down": _w((lambda *s: torch.randn(*s, dtype=torch.bfloat16) * 0.8)(F, D) * (1.0 / F) ** 0.5),
        }
    _B_in = _B_setup()

    return {
        "A_x": _A_in["x"],
        "A_wqkv": _A_in["wqkv"],
        "A_wo": _A_in["wo"],
        "B_x": _B_in["x"],
        "B_W_gate": _B_in["W_gate"],
        "B_W_up": _B_in["W_up"],
        "B_W_down": _B_in["W_down"],
    }

def reference(A_x, A_wqkv, A_wo, B_x, B_W_gate, B_W_up, B_W_down):
    def _A_ref(x, wqkv, wo):
        B, S, D = x.shape
        H = 32; Dh = D // H; W = 256
        qkv = (lambda x, *d: x.permute(*d))((x @ wqkv).reshape(B, S, 3, H, Dh), 2, 0, 3, 1, 4)
        q, k, v = qkv[0], qkv[1], qkv[2]
        scores = torch.einsum("bhqd,bhkd->bhqk", q, k) * (Dh ** -0.5)
        idx = torch.arange(S)
        mask = (idx[:, None] - idx[None, :] >= 0) & (idx[:, None] - idx[None, :] < W)
        scores = torch.where(mask[None, None], scores, -1e9)
        p = _softmax(scores, axis=-1)
        o = torch.einsum("bhqk,bhkd->bhqd", p, v)
        return (lambda x, *d: x.permute(*d))(o, 0, 2, 1, 3).reshape(B, S, D) @ wo

    def _B_ref(x, W_gate, W_up, W_down):
        gate = torch.einsum("bsd,df->bsf", x, W_gate)
        up = torch.einsum("bsd,df->bsf", x, W_up)
        gate = gate * (lambda x, dt: x.to(dt))(gate > 0, gate.dtype)
        h = gate * up
        return torch.einsum("bsf,fd->bsd", h, W_down)

    x = A_x
    xn = _layernorm(x, axis=-1)
    return x + _A_ref(xn, A_wqkv, A_wo) + _B_ref(xn, B_W_gate, B_W_up, B_W_down)
```

```asm
; @launch grid=(256,1,1) block=(512,1,1) lds=163840
.amdgcn_target "amdgcn-amd-amdhsa--gfx950"
.text
.globl parallel_sum__sliding_block__glu_gated_reglu__prompt_kernel
.p2align 8
.type parallel_sum__sliding_block__glu_gated_reglu__prompt_kernel,@function
parallel_sum__sliding_block__glu_gated_reglu__prompt_kernel:
  s_cmp_ge_u32 s2, 256
  s_cbranch_scc1 L_END
  s_load_dwordx16 s[4:19], s[0:1], 0
  s_load_dwordx4 s[20:23], s[0:1], 64
  s_getpc_b64 s[50:51]
L_PC:
  v_lshlrev_b32 v2, 7, v0
  v_min_u32 v2, L_END-L_PC, v2
  global_load_dword v251, v2, s[50:51]
  v_lshrrev_b32 v1, 6, v0
  v_and_b32 v0, 63, v0
  v_readfirstlane_b32 s36, v1
  s_and_b32 s42, s2, 3
  s_lshl_b32 s42, s42, 2
  s_bfe_u32 s43, s2, 131075
  s_add_u32 s39, s42, s43
  s_bfe_u32 s42, s2, 65538
  s_lshl_b32 s42, s42, 3
  s_lshr_b32 s43, s2, 5
  s_add_u32 s40, s42, s43
  s_and_b32 s37, s36, 3
  s_lshr_b32 s38, s36, 2
  s_mul_i32 s63, s40, 6
  s_min_u32 s63, s63, 80
  v_mov_b32 v254, 0
  s_mov_b32 s3, 0
  s_cmp_eq_u32 s38, 0
  s_cbranch_scc1 L_P0
  s_lshl_b32 s60, s37, 12
  v_lshrrev_b32 v3, 3, v0
  s_lshl_b32 s42, s37, 5
  v_add_u32 v4, s42, v3
  v_lshrrev_b32 v5, 1, v4
  v_xor_b32 v5, v5, v0
  v_and_b32 v5, 7, v5
  v_lshlrev_b32 v5, 4, v5
  v_lshl_add_u32 v1, v4, 10, v5
  v_xor_b32 v2, 64, v1
  v_add_u32 v2, 7168, v2
  s_mul_i32 s61, s37, 3072
  s_mul_i32 s50, s37, 49152
  s_mul_i32 s51, s40, 192
  s_add_u32 s50, s50, s51
  v_add_u32 v3, 0, v0
  v_mul_u32_u24 v4, 5462, v3
  v_lshrrev_b32 v4, 16, v4
  v_mul_u32_u24 v4, 2880, v4
  v_lshl_add_u32 v4, v3, 4, v4
  s_sub_u32 s48, s50, 0
  v_add_u32 v32, s48, v4
  v_add_u32 v3, 64, v0
  v_mul_u32_u24 v4, 5462, v3
  v_lshrrev_b32 v4, 16, v4
  v_mul_u32_u24 v4, 2880, v4
  v_lshl_add_u32 v4, v3, 4, v4
  s_sub_u32 s48, s50, 1024
  v_add_u32 v33, s48, v4
  v_add_u32 v3, 128, v0
  v_mul_u32_u24 v4, 5462, v3
  v_lshrrev_b32 v4, 16, v4
  v_mul_u32_u24 v4, 2880, v4
  v_lshl_add_u32 v4, v3, 4, v4
  s_sub_u32 s48, s50, 2048
  v_add_u32 v34, s48, v4
  s_waitcnt lgkmcnt(0)
  s_lshl_b32 s42, s39, 17
  s_add_u32 s24, s4, s42
  s_addc_u32 s25, s5, 0
  s_mov_b32 s26, 131072
  s_mov_b32 s27, 131072
  s_mov_b32 s28, s6
  s_mov_b32 s29, s7
  s_mov_b32 s30, 1572864
  s_mov_b32 s31, 131072
  s_mov_b32 s32, s22
  s_mov_b32 s33, s23
  s_mov_b32 s34, 15073280
  s_mov_b32 s35, 131072
  s_mov_b32 s56, s20
  s_mov_b32 s57, s21
  s_mov_b32 s58, 256
  s_mov_b32 s59, 131072
  s_add_u32 m0, s60, 0
  s_mov_b32 s41, 0
  buffer_load_dwordx4 v1, s[24:27], s41 offen lds
  buffer_load_dwordx4 v2, s[24:27], s41 offen offset:1024 lds
  s_add_u32 s41, s41, 14336
  buffer_load_dwordx4 v1, s[24:27], s41 offen offset:2048 lds
  buffer_load_dwordx4 v2, s[24:27], s41 offen offset:3072 lds
  s_add_u32 m0, s61, 16384
  s_mov_b32 s41, 0
  buffer_load_dwordx4 v32, s[28:31], s41 offen lds
  buffer_load_dwordx4 v33, s[28:31], s41 offen offset:1024 lds
  buffer_load_dwordx4 v34, s[28:31], s41 offen offset:2048 lds
  s_or_b32 s42, s2, s37
  s_cmp_lg_u32 s42, 0
  s_cbranch_scc1 L_NL
  s_memrealtime s[48:49]
  s_waitcnt lgkmcnt(0)
  s_or_b32 s49, s49, 0x80000000
  v_mov_b32 v252, s48
  v_mov_b32 v253, s49
  s_mov_b64 exec, 1
  buffer_store_dwordx2 v[252:253], v254, s[56:59], 0 offen sc1
  s_mov_b64 exec, -1
L_NL:
  s_add_u32 m0, s60, 28672
  s_mov_b32 s41, 128
  buffer_load_dwordx4 v1, s[24:27], s41 offen lds
  buffer_load_dwordx4 v2, s[24:27], s41 offen offset:1024 lds
  s_add_u32 s41, s41, 14336
  buffer_load_dwordx4 v1, s[24:27], s41 offen offset:2048 lds
  buffer_load_dwordx4 v2, s[24:27], s41 offen offset:3072 lds
  s_add_u32 m0, s61, 45056
  s_mov_b32 s41, 196608
  buffer_load_dwordx4 v32, s[28:31], s41 offen lds
  buffer_load_dwordx4 v33, s[28:31], s41 offen offset:1024 lds
  buffer_load_dwordx4 v34, s[28:31], s41 offen offset:2048 lds
  v_and_b32 v3, 31, v0
  s_lshl_b32 s42, s37, 5
  v_add_u32 v3, s42, v3
  v_lshrrev_b32 v4, 1, v3
  v_lshrrev_b32 v5, 5, v0
  v_xor_b32 v4, v4, v5
  v_and_b32 v4, 7, v4
  v_lshlrev_b32 v4, 4, v4
  v_lshl_add_u32 v44, v3, 7, v4
  v_xor_b32 v45, 32, v44
  v_xor_b32 v46, 64, v44
  v_xor_b32 v47, 96, v44
  s_cmp_lt_u32 s37, 2
  s_cselect_b32 s52, s12, s14
  s_cselect_b32 s53, s13, s15
  s_cmp_lt_u32 s40, 15
  s_cselect_b32 s54, 1409024, 0
  s_mov_b32 s55, 131072
  s_and_b32 s50, s37, 1
  s_mul_i32 s62, s50, 6144
  s_lshr_b32 s51, s37, 1
  s_mul_i32 s51, s51, 12320
  s_add_u32 s62, s62, s51
  s_mul_i32 s50, s50, 88064
  s_lshl_b32 s51, s63, 5
  s_add_u32 s50, s50, s51
  v_add_u32 v3, 0, v0
  v_mul_u32_u24 v4, 5462, v3
  v_lshrrev_b32 v4, 16, v4
  v_mul_u32_u24 v4, 2560, v4
  v_lshl_add_u32 v4, v3, 4, v4
  s_sub_u32 s48, s50, 0
  v_add_u32 v36, s48, v4
  v_add_u32 v3, 64, v0
  v_mul_u32_u24 v4, 5462, v3
  v_lshrrev_b32 v4, 16, v4
  v_mul_u32_u24 v4, 2560, v4
  v_lshl_add_u32 v4, v3, 4, v4
  s_sub_u32 s48, s50, 1024
  v_add_u32 v37, s48, v4
  v_add_u32 v3, 128, v0
  v_mul_u32_u24 v4, 5462, v3
  v_lshrrev_b32 v4, 16, v4
  v_mul_u32_u24 v4, 2560, v4
  v_lshl_add_u32 v4, v3, 4, v4
  s_sub_u32 s48, s50, 2048
  v_add_u32 v38, s48, v4
  v_add_u32 v3, 192, v0
  v_mul_u32_u24 v4, 5462, v3
  v_lshrrev_b32 v4, 16, v4
  v_mul_u32_u24 v4, 2560, v4
  v_lshl_add_u32 v4, v3, 4, v4
  s_sub_u32 s48, s50, 3072
  v_add_u32 v39, s48, v4
  v_add_u32 v3, 256, v0
  v_mul_u32_u24 v4, 5462, v3
  v_lshrrev_b32 v4, 16, v4
  v_mul_u32_u24 v4, 2560, v4
  v_lshl_add_u32 v4, v3, 4, v4
  s_sub_u32 s48, s50, 0
  v_add_u32 v40, s48, v4
  v_add_u32 v3, 320, v0
  v_mul_u32_u24 v4, 5462, v3
  v_lshrrev_b32 v4, 16, v4
  v_mul_u32_u24 v4, 2560, v4
  v_lshl_add_u32 v4, v3, 4, v4
  s_sub_u32 s48, s50, 1024
  v_add_u32 v41, s48, v4
  s_waitcnt vmcnt(7) lgkmcnt(0)
  s_barrier
  s_add_u32 m0, s60, 57344
  s_mov_b32 s41, 256
  buffer_load_dwordx4 v1, s[24:27], s41 offen lds
  buffer_load_dwordx4 v2, s[24:27], s41 offen offset:1024 lds
  ds_read_b128 v[128:131], v44 offset:0
  ds_read_b128 v[132:135], v45 offset:0
  ds_read_b128 v[136:139], v46 offset:0
  ds_read_b128 v[140:143], v47 offset:0
  s_add_u32 s41, s41, 14336
  buffer_load_dwordx4 v1, s[24:27], s41 offen offset:2048 lds
  buffer_load_dwordx4 v2, s[24:27], s41 offen offset:3072 lds
  s_add_u32 m0, s61, 73728
  s_mov_b32 s41, 393216
  buffer_load_dwordx4 v32, s[28:31], s41 offen lds
  buffer_load_dwordx4 v33, s[28:31], s41 offen offset:1024 lds
  buffer_load_dwordx4 v34, s[28:31], s41 offen offset:2048 lds
  s_waitcnt vmcnt(7) lgkmcnt(0)
  s_barrier
  s_add_u32 m0, s60, 0
  s_mov_b32 s41, 384
  buffer_load_dwordx4 v1, s[24:27], s41 offen lds
  buffer_load_dwordx4 v2, s[24:27], s41 offen offset:1024 lds
  ds_read_b128 v[144:147], v44 offset:28672
  ds_read_b128 v[148:151], v45 offset:28672
  ds_read_b128 v[152:155], v46 offset:28672
  ds_read_b128 v[156:159], v47 offset:28672
  s_add_u32 s41, s41, 14336
  buffer_load_dwordx4 v1, s[24:27], s41 offen offset:2048 lds
  buffer_load_dwordx4 v2, s[24:27], s41 offen offset:3072 lds
  s_add_u32 m0, s61, 16384
  s_mov_b32 s41, 589824
  buffer_load_dwordx4 v32, s[28:31], s41 offen lds
  buffer_load_dwordx4 v33, s[28:31], s41 offen offset:1024 lds
  buffer_load_dwordx4 v34, s[28:31], s41 offen offset:2048 lds
  s_waitcnt vmcnt(7) lgkmcnt(0)
  s_barrier
  s_add_u32 m0, s60, 28672
  s_mov_b32 s41, 512
  buffer_load_dwordx4 v1, s[24:27], s41 offen lds
  buffer_load_dwordx4 v2, s[24:27], s41 offen offset:1024 lds
  ds_read_b128 v[160:163], v44 offset:57344
  ds_read_b128 v[164:167], v45 offset:57344
  ds_read_b128 v[168:171], v46 offset:57344
  ds_read_b128 v[172:175], v47 offset:57344
  s_add_u32 s41, s41, 14336
  buffer_load_dwordx4 v1, s[24:27], s41 offen offset:2048 lds
  buffer_load_dwordx4 v2, s[24:27], s41 offen offset:3072 lds
  s_add_u32 m0, s61, 45056
  s_mov_b32 s41, 786432
  buffer_load_dwordx4 v32, s[28:31], s41 offen lds
  buffer_load_dwordx4 v33, s[28:31], s41 offen offset:1024 lds
  buffer_load_dwordx4 v34, s[28:31], s41 offen offset:2048 lds
  s_waitcnt vmcnt(7) lgkmcnt(0)
  s_barrier
  s_add_u32 m0, s60, 57344
  s_mov_b32 s41, 640
  buffer_load_dwordx4 v1, s[24:27], s41 offen lds
  buffer_load_dwordx4 v2, s[24:27], s41 offen offset:1024 lds
  ds_read_b128 v[176:179], v44 offset:0
  ds_read_b128 v[180:183], v45 offset:0
  ds_read_b128 v[184:187], v46 offset:0
  ds_read_b128 v[188:191], v47 offset:0
  s_add_u32 s41, s41, 14336
  buffer_load_dwordx4 v1, s[24:27], s41 offen offset:2048 lds
  buffer_load_dwordx4 v2, s[24:27], s41 offen offset:3072 lds
  s_add_u32 m0, s61, 73728
  s_mov_b32 s41, 983040
  buffer_load_dwordx4 v32, s[28:31], s41 offen lds
  buffer_load_dwordx4 v33, s[28:31], s41 offen offset:1024 lds
  buffer_load_dwordx4 v34, s[28:31], s41 offen offset:2048 lds
  s_waitcnt vmcnt(7) lgkmcnt(0)
  s_barrier
  s_add_u32 m0, s60, 0
  s_mov_b32 s41, 768
  buffer_load_dwordx4 v1, s[24:27], s41 offen lds
  buffer_load_dwordx4 v2, s[24:27], s41 offen offset:1024 lds
  ds_read_b128 v[192:195], v44 offset:28672
  ds_read_b128 v[196:199], v45 offset:28672
  ds_read_b128 v[200:203], v46 offset:28672
  ds_read_b128 v[204:207], v47 offset:28672
  s_add_u32 s41, s41, 14336
  buffer_load_dwordx4 v1, s[24:27], s41 offen offset:2048 lds
  buffer_load_dwordx4 v2, s[24:27], s41 offen offset:3072 lds
  s_add_u32 m0, s61, 16384
  s_mov_b32 s41, 1179648
  buffer_load_dwordx4 v32, s[28:31], s41 offen lds
  buffer_load_dwordx4 v33, s[28:31], s41 offen offset:1024 lds
  buffer_load_dwordx4 v34, s[28:31], s41 offen offset:2048 lds
  s_waitcnt vmcnt(7) lgkmcnt(0)
  s_barrier
  s_add_u32 m0, s60, 28672
  s_mov_b32 s41, 896
  buffer_load_dwordx4 v1, s[24:27], s41 offen lds
  buffer_load_dwordx4 v2, s[24:27], s41 offen offset:1024 lds
  ds_read_b128 v[208:211], v44 offset:57344
  ds_read_b128 v[212:215], v45 offset:57344
  ds_read_b128 v[216:219], v46 offset:57344
  ds_read_b128 v[220:223], v47 offset:57344
  s_add_u32 s41, s41, 14336
  buffer_load_dwordx4 v1, s[24:27], s41 offen offset:2048 lds
  buffer_load_dwordx4 v2, s[24:27], s41 offen offset:3072 lds
  s_add_u32 m0, s61, 45056
  s_mov_b32 s41, 1376256
  buffer_load_dwordx4 v32, s[28:31], s41 offen lds
  buffer_load_dwordx4 v33, s[28:31], s41 offen offset:1024 lds
  buffer_load_dwordx4 v34, s[28:31], s41 offen offset:2048 lds
  s_waitcnt vmcnt(7) lgkmcnt(0)
  s_barrier
  s_add_u32 m0, s62, 98816
  s_mov_b32 s41, 0
  buffer_load_dwordx4 v36, s[52:55], s41 offen lds
  buffer_load_dwordx4 v37, s[52:55], s41 offen offset:1024 lds
  ds_read_b128 v[224:227], v44 offset:0
  ds_read_b128 v[228:231], v45 offset:0
  ds_read_b128 v[232:235], v46 offset:0
  ds_read_b128 v[236:239], v47 offset:0
  buffer_load_dwordx4 v38, s[52:55], s41 offen offset:2048 lds
  buffer_load_dwordx4 v39, s[52:55], s41 offen offset:3072 lds
  s_add_u32 m0, s62, 102912
  s_nop 0
  buffer_load_dwordx4 v40, s[52:55], s41 offen lds
  buffer_load_dwordx4 v41, s[52:55], s41 offen offset:1024 lds
  s_add_u32 m0, s62, 123520
  s_mov_b32 s41, 176128
  buffer_load_dwordx4 v36, s[52:55], s41 offen lds
  buffer_load_dwordx4 v37, s[52:55], s41 offen offset:1024 lds
  buffer_load_dwordx4 v38, s[52:55], s41 offen offset:2048 lds
  buffer_load_dwordx4 v39, s[52:55], s41 offen offset:3072 lds
  s_add_u32 m0, s62, 127616
  s_nop 0
  buffer_load_dwordx4 v40, s[52:55], s41 offen lds
  buffer_load_dwordx4 v41, s[52:55], s41 offen offset:1024 lds
  s_waitcnt vmcnt(12) lgkmcnt(0)
  s_barrier
  s_add_u32 m0, s62, 74112
  s_mov_b32 s41, 352256
  buffer_load_dwordx4 v36, s[52:55], s41 offen lds
  buffer_load_dwordx4 v37, s[52:55], s41 offen offset:1024 lds
  ds_read_b128 v[240:243], v44 offset:28672
  ds_read_b128 v[244:247], v45 offset:28672
  ds_read_b128 v[248:251], v46 offset:28672
  ds_read_b128 v[252:255], v47 offset:28672
  buffer_load_dwordx4 v38, s[52:55], s41 offen offset:2048 lds
  buffer_load_dwordx4 v39, s[52:55], s41 offen offset:3072 lds
  s_add_u32 m0, s62, 78208
  s_nop 0
  buffer_load_dwordx4 v40, s[52:55], s41 offen lds
  buffer_load_dwordx4 v41, s[52:55], s41 offen offset:1024 lds
  s_add_u32 m0, s62, 0
  s_mov_b32 s41, 528384
  buffer_load_dwordx4 v36, s[52:55], s41 offen lds
  buffer_load_dwordx4 v37, s[52:55], s41 offen offset:1024 lds
  buffer_load_dwordx4 v38, s[52:55], s41 offen offset:2048 lds
  buffer_load_dwordx4 v39, s[52:55], s41 offen offset:3072 lds
  s_add_u32 m0, s62, 4096
  s_nop 0
  buffer_load_dwordx4 v40, s[52:55], s41 offen lds
  buffer_load_dwordx4 v41, s[52:55], s41 offen offset:1024 lds
  v_lshrrev_b32 v6, 5, v0
  v_lshlrev_b32 v6, 3, v6
  v_bfe_u32 v7, v0, 2, 2
  v_add_u32 v6, v6, v7
  v_mul_u32_u24 v6, 192, v6
  v_and_b32 v7, 3, v0
  v_lshl_add_u32 v6, v7, 3, v6
  v_bfe_u32 v7, v0, 4, 1
  v_mul_u32_u24 v7, 12320, v7
  v_add_u32 v1, v6, v7
  v_add_u32 v2, 49408, v1
  v_add_u32 v3, 98816, v1
  v_mov_b32 v4, 163712
  s_lshl_b32 s42, s37, 2
  s_add_u32 s42, s42, 163728
  v_mov_b32 v5, s42
  s_mov_b32 s76, s16
  s_mov_b32 s77, s17
  s_mov_b32 s78, 1409024
  s_mov_b32 s79, 131072
  v_bfe_u32 v6, v0, 4, 1
  v_lshlrev_b32 v6, 2, v6
  v_xor_b32 v6, v6, v0
  v_and_b32 v6, 7, v6
  v_lshlrev_b32 v6, 4, v6
  v_lshrrev_b32 v7, 3, v0
  v_lshl_add_u32 v7, v7, 10, v6
  s_and_b32 s43, s2, 1
  s_lshl_b32 s43, s43, 2
  s_lshr_b32 s42, s2, 6
  s_add_u32 s42, s42, s43
  s_lshl_b32 s42, s42, 7
  s_mul_i32 s43, s37, 360448
  s_add_u32 s43, s43, s42
  v_add_u32 v7, s43, v7
  s_mul_i32 s86, s37, 18432
  s_waitcnt vmcnt(18) lgkmcnt(0)
  s_barrier
  s_setprio 2
  ds_read_b64_tr_b16 v[8:9], v3 offset:0
  ds_read_b64_tr_b16 v[10:11], v3 offset:768
  ds_read_b64_tr_b16 v[12:13], v3 offset:32
  ds_read_b64_tr_b16 v[14:15], v3 offset:800
  ds_read_b64_tr_b16 v[16:17], v3 offset:64
  ds_read_b64_tr_b16 v[18:19], v3 offset:832
  ds_read_b64_tr_b16 v[20:21], v3 offset:96
  ds_read_b64_tr_b16 v[22:23], v3 offset:864
  ds_read_b64_tr_b16 v[24:25], v3 offset:128
  ds_read_b64_tr_b16 v[26:27], v3 offset:896
  s_waitcnt lgkmcnt(8)
  v_mfma_f32_32x32x16_bf16 v[32:47], v[8:11], v[128:131], 0
  ds_read_b64_tr_b16 v[8:9], v3 offset:160
  ds_read_b64_tr_b16 v[10:11], v3 offset:928
  s_waitcnt lgkmcnt(8)
  v_mfma_f32_32x32x16_bf16 v[48:63], v[12:15], v[128:131], 0
  ds_read_b64_tr_b16 v[12:13], v3 offset:3072
  ds_read_b64_tr_b16 v[14:15], v3 offset:3840
  s_waitcnt lgkmcnt(8)
  v_mfma_f32_32x32x16_bf16 v[64:79], v[16:19], v[128:131], 0
  ds_read_b64_tr_b16 v[16:17], v3 offset:3104
  ds_read_b64_tr_b16 v[18:19], v3 offset:3872
  s_waitcnt lgkmcnt(8)
  v_mfma_f32_32x32x16_bf16 v[80:95], v[20:23], v[128:131], 0
  s_waitcnt vmcnt(12)
  v_mov_b32 v6, 9
  ds_write_b32 v5, v6 offset:48
  ds_read_b64_tr_b16 v[20:21], v3 offset:3136
  ds_read_b64_tr_b16 v[22:23], v3 offset:3904
  s_waitcnt lgkmcnt(9)
  v_mfma_f32_32x32x16_bf16 v[96:111], v[24:27], v[128:131], 0
  ds_read_b64_tr_b16 v[24:25], v3 offset:3168
  ds_read_b64_tr_b16 v[26:27], v3 offset:3936
  s_waitcnt lgkmcnt(9)
  v_mfma_f32_32x32x16_bf16 v[112:127], v[8:11], v[128:131], 0
  ds_read_b64_tr_b16 v[8:9], v3 offset:3200
  ds_read_b64_tr_b16 v[10:11], v3 offset:3968
  s_waitcnt lgkmcnt(9)
  v_mfma_f32_32x32x16_bf16 v[32:47], v[12:15], v[132:135], v[32:47]
  ds_read_b64_tr_b16 v[12:13], v3 offset:3232
  ds_read_b64_tr_b16 v[14:15], v3 offset:4000
  s_waitcnt lgkmcnt(9)
  v_mfma_f32_32x32x16_bf16 v[48:63], v[16:19], v[132:135], v[48:63]
  ds_read_b64_tr_b16 v[16:17], v3 offset:6144
  ds_read_b64_tr_b16 v[18:19], v3 offset:6912
  s_waitcnt lgkmcnt(8)
  v_mfma_f32_32x32x16_bf16 v[64:79], v[20:23], v[132:135], v[64:79]
  ds_read_b64_tr_b16 v[20:21], v3 offset:6176
  ds_read_b64_tr_b16 v[22:23], v3 offset:6944
  s_waitcnt lgkmcnt(8)
  v_mfma_f32_32x32x16_bf16 v[80:95], v[24:27], v[132:135], v[80:95]
  ds_read_b64_tr_b16 v[24:25], v3 offset:6208
  ds_read_b64_tr_b16 v[26:27], v3 offset:6976
  s_waitcnt lgkmcnt(8)
  v_mfma_f32_32x32x16_bf16 v[96:111], v[8:11], v[132:135], v[96:111]
  ds_read_b64_tr_b16 v[8:9], v3 offset:6240
  ds_read_b64_tr_b16 v[10:11], v3 offset:7008
  s_waitcnt lgkmcnt(8)
  v_mfma_f32_32x32x16_bf16 v[112:127], v[12:15], v[132:135], v[112:127]
  ds_read_b64_tr_b16 v[12:13], v3 offset:6272
  ds_read_b64_tr_b16 v[14:15], v3 offset:7040
  s_waitcnt lgkmcnt(8)
  v_mfma_f32_32x32x16_bf16 v[32:47], v[16:19], v[136:139], v[32:47]
  ds_read_b128 v[28:31], v4 offset:64
  ds_read_b64_tr_b16 v[16:17], v3 offset:6304
  ds_read_b64_tr_b16 v[18:19], v3 offset:7072
  s_waitcnt lgkmcnt(9)
  v_mfma_f32_32x32x16_bf16 v[48:63], v[20:23], v[136:139], v[48:63]
  ds_read_b64_tr_b16 v[20:21], v3 offset:9216
  ds_read_b64_tr_b16 v[22:23], v3 offset:9984
  s_waitcnt lgkmcnt(9)
  v_mfma_f32_32x32x16_bf16 v[64:79], v[24:27], v[136:139], v[64:79]
  ds_read_b64_tr_b16 v[24:25], v3 offset:9248
  ds_read_b64_tr_b16 v[26:27], v3 offset:10016
  s_waitcnt lgkmcnt(9)
  v_mfma_f32_32x32x16_bf16 v[80:95], v[8:11], v[136:139], v[80:95]
  ds_read_b64_tr_b16 v[8:9], v3 offset:9280
  ds_read_b64_tr_b16 v[10:11], v3 offset:10048
  s_waitcnt lgkmcnt(9)
  v_mfma_f32_32x32x16_bf16 v[96:111], v[12:15], v[136:139], v[96:111]
  ds_read_b64_tr_b16 v[12:13], v3 offset:9312
  ds_read_b64_tr_b16 v[14:15], v3 offset:10080
  s_waitcnt lgkmcnt(8)
  v_mfma_f32_32x32x16_bf16 v[112:127], v[16:19], v[136:139], v[112:127]
  ds_read_b64_tr_b16 v[16:17], v3 offset:9344
  ds_read_b64_tr_b16 v[18:19], v3 offset:10112
  s_waitcnt lgkmcnt(8)
  v_mfma_f32_32x32x16_bf16 v[32:47], v[20:23], v[140:143], v[32:47]
  v_min3_u32 v28, v28, v29, v30
  v_min_u32 v28, v28, v31
  v_cmp_gt_u32 vcc, 9, v28
  ds_read_b64_tr_b16 v[20:21], v3 offset:9376
  ds_read_b64_tr_b16 v[22:23], v3 offset:10144
  s_waitcnt lgkmcnt(8)
  v_mfma_f32_32x32x16_bf16 v[48:63], v[24:27], v[140:143], v[48:63]
lsp_9b20_1001:
  s_nop 0
  s_cbranch_vccz lok_9b20_1002
  s_add_u32 s3, s3, 1
  s_cmp_gt_u32 s3, 4194304
  s_cbranch_scc1 lok_9b20_1002
  ds_read_b128 v[28:31], v4 offset:64
  s_waitcnt lgkmcnt(0)
  v_min3_u32 v28, v28, v29, v30
  v_min_u32 v28, v28, v31
  v_cmp_gt_u32 vcc, 9, v28
  s_nop 4
  s_branch lsp_9b20_1001
lok_9b20_1002:
  ds_read_b64_tr_b16 v[24:25], v3 offset:24704
  ds_read_b64_tr_b16 v[26:27], v3 offset:25472
  s_waitcnt lgkmcnt(8)
  v_mfma_f32_32x32x16_bf16 v[64:79], v[8:11], v[140:143], v[64:79]
  ds_read_b64_tr_b16 v[8:9], v3 offset:24736
  ds_read_b64_tr_b16 v[10:11], v3 offset:25504
  s_waitcnt lgkmcnt(8)
  v_mfma_f32_32x32x16_bf16 v[80:95], v[12:15], v[140:143], v[80:95]
  ds_read_b64_tr_b16 v[12:13], v3 offset:24768
  ds_read_b64_tr_b16 v[14:15], v3 offset:25536
  s_waitcnt lgkmcnt(8)
  v_mfma_f32_32x32x16_bf16 v[96:111], v[16:19], v[140:143], v[96:111]
  ds_read_b64_tr_b16 v[16:17], v3 offset:24800
  ds_read_b64_tr_b16 v[18:19], v3 offset:25568
  s_waitcnt lgkmcnt(8)
  v_mfma_f32_32x32x16_bf16 v[112:127], v[20:23], v[140:143], v[112:127]
  v_mov_b32 v6, 8
  ds_write_b32 v5, v6 offset:0
  ds_read_b64_tr_b16 v[20:21], v3 offset:24832
  ds_read_b64_tr_b16 v[22:23], v3 offset:25600
  s_waitcnt lgkmcnt(9)
  v_mfma_f32_32x32x16_bf16 v[32:47], v[24:27], v[144:147], v[32:47]
  ds_read_b64_tr_b16 v[24:25], v3 offset:24864
  ds_read_b64_tr_b16 v[26:27], v3 offset:25632
  s_waitcnt lgkmcnt(9)
  v_mfma_f32_32x32x16_bf16 v[48:63], v[8:11], v[144:147], v[48:63]
  ds_read_b64_tr_b16 v[8:9], v3 offset:27776
  ds_read_b64_tr_b16 v[10:11], v3 offset:28544
  s_waitcnt lgkmcnt(9)
  v_mfma_f32_32x32x16_bf16 v[64:79], v[12:15], v[144:147], v[64:79]
  ds_read_b64_tr_b16 v[12:13], v3 offset:27808
  ds_read_b64_tr_b16 v[14:15], v3 offset:28576
  s_waitcnt lgkmcnt(9)
  v_mfma_f32_32x32x16_bf16 v[80:95], v[16:19], v[144:147], v[80:95]
  s_waitcnt vmcnt(6)
  v_mov_b32 v6, 10
  ds_write_b32 v5, v6 offset:48
  ds_read_b64_tr_b16 v[16:17], v3 offset:27840
  ds_read_b64_tr_b16 v[18:19], v3 offset:28608
  s_waitcnt lgkmcnt(9)
  v_mfma_f32_32x32x16_bf16 v[96:111], v[20:23], v[144:147], v[96:111]
  ds_read_b64_tr_b16 v[20:21], v3 offset:27872
  ds_read_b64_tr_b16 v[22:23], v3 offset:28640
  s_waitcnt lgkmcnt(9)
  v_mfma_f32_32x32x16_bf16 v[112:127], v[24:27], v[144:147], v[112:127]
  ds_read_b64_tr_b16 v[24:25], v3 offset:27904
  ds_read_b64_tr_b16 v[26:27], v3 offset:28672
  s_waitcnt lgkmcnt(9)
  v_mfma_f32_32x32x16_bf16 v[32:47], v[8:11], v[148:151], v[32:47]
  ds_read_b64_tr_b16 v[8:9], v3 offset:27936
  ds_read_b64_tr_b16 v[10:11], v3 offset:28704
  s_waitcnt lgkmcnt(9)
  v_mfma_f32_32x32x16_bf16 v[48:63], v[12:15], v[148:151], v[48:63]
  ds_read_b64_tr_b16 v[12:13], v3 offset:30848
  ds_read_b64_tr_b16 v[14:15], v3 offset:31616
  s_waitcnt lgkmcnt(8)
  v_mfma_f32_32x32x16_bf16 v[64:79], v[16:19], v[148:151], v[64:79]
  ds_read_b64_tr_b16 v[16:17], v3 offset:30880
  ds_read_b64_tr_b16 v[18:19], v3 offset:31648
  s_waitcnt lgkmcnt(8)
  v_mfma_f32_32x32x16_bf16 v[80:95], v[20:23], v[148:151], v[80:95]
  ds_read_b64_tr_b16 v[20:21], v3 offset:30912
  ds_read_b64_tr_b16 v[22:23], v3 offset:31680
  s_waitcnt lgkmcnt(8)
  v_mfma_f32_32x32x16_bf16 v[96:111], v[24:27], v[148:151], v[96:111]
  ds_read_b64_tr_b16 v[24:25], v3 offset:30944
  ds_read_b64_tr_b16 v[26:27], v3 offset:31712
  s_waitcnt lgkmcnt(8)
  v_mfma_f32_32x32x16_bf16 v[112:127], v[8:11], v[148:151], v[112:127]
  ds_read_b64_tr_b16 v[8:9], v3 offset:30976
  ds_read_b64_tr_b16 v[10:11], v3 offset:31744
  s_waitcnt lgkmcnt(8)
  v_mfma_f32_32x32x16_bf16 v[32:47], v[12:15], v[152:155], v[32:47]
  ds_read_b128 v[28:31], v4 offset:64
  ds_read_b64_tr_b16 v[12:13], v3 offset:31008
  ds_read_b64_tr_b16 v[14:15], v3 offset:31776
  s_waitcnt lgkmcnt(9)
  v_mfma_f32_32x32x16_bf16 v[48:63], v[16:19], v[152:155], v[48:63]
  ds_read_b64_tr_b16 v[16:17], v3 offset:33920
  ds_read_b64_tr_b16 v[18:19], v3 offset:34688
  s_waitcnt lgkmcnt(9)
  v_mfma_f32_32x32x16_bf16 v[64:79], v[20:23], v[152:155], v[64:79]
  ds_read_b64_tr_b16 v[20:21], v3 offset:33952
  ds_read_b64_tr_b16 v[22:23], v3 offset:34720
  s_waitcnt lgkmcnt(9)
  v_mfma_f32_32x32x16_bf16 v[80:95], v[24:27], v[152:155], v[80:95]
  ds_read_b64_tr_b16 v[24:25], v3 offset:33984
  ds_read_b64_tr_b16 v[26:27], v3 offset:34752
  s_waitcnt lgkmcnt(9)
  v_mfma_f32_32x32x16_bf16 v[96:111], v[8:11], v[152:155], v[96:111]
  ds_read_b64_tr_b16 v[8:9], v3 offset:34016
  ds_read_b64_tr_b16 v[10:11], v3 offset:34784
  s_waitcnt lgkmcnt(8)
  v_mfma_f32_32x32x16_bf16 v[112:127], v[12:15], v[152:155], v[112:127]
  ds_read_b64_tr_b16 v[12:13], v3 offset:34048
  ds_read_b64_tr_b16 v[14:15], v3 offset:34816
  s_waitcnt lgkmcnt(8)
  v_mfma_f32_32x32x16_bf16 v[32:47], v[16:19], v[156:159], v[32:47]
  v_min3_u32 v28, v28, v29, v30
  v_min_u32 v28, v28, v31
  v_cmp_gt_u32 vcc, 10, v28
  ds_read_b64_tr_b16 v[16:17], v3 offset:34080
  ds_read_b64_tr_b16 v[18:19], v3 offset:34848
  s_waitcnt lgkmcnt(8)
  v_mfma_f32_32x32x16_bf16 v[48:63], v[20:23], v[156:159], v[48:63]
lsp_9b20_1003:
  s_nop 0
  s_cbranch_vccz lok_9b20_1004
  s_add_u32 s3, s3, 1
  s_cmp_gt_u32 s3, 4194304
  s_cbranch_scc1 lok_9b20_1004
  ds_read_b128 v[28:31], v4 offset:64
  s_waitcnt lgkmcnt(0)
  v_min3_u32 v28, v28, v29, v30
  v_min_u32 v28, v28, v31
  v_cmp_gt_u32 vcc, 10, v28
  s_nop 4
  s_branch lsp_9b20_1003
lok_9b20_1004:
  ds_read_b64_tr_b16 v[20:21], v2 offset:24704
  ds_read_b64_tr_b16 v[22:23], v2 offset:25472
  s_waitcnt lgkmcnt(8)
  v_mfma_f32_32x32x16_bf16 v[64:79], v[24:27], v[156:159], v[64:79]
  ds_read_b64_tr_b16 v[24:25], v2 offset:24736
  ds_read_b64_tr_b16 v[26:27], v2 offset:25504
  s_waitcnt lgkmcnt(8)
  v_mfma_f32_32x32x16_bf16 v[80:95], v[8:11], v[156:159], v[80:95]
  ds_read_b64_tr_b16 v[8:9], v2 offset:24768
  ds_read_b64_tr_b16 v[10:11], v2 offset:25536
  s_waitcnt lgkmcnt(8)
  v_mfma_f32_32x32x16_bf16 v[96:111], v[12:15], v[156:159], v[96:111]
  ds_read_b64_tr_b16 v[12:13], v2 offset:24800
  ds_read_b64_tr_b16 v[14:15], v2 offset:25568
  s_waitcnt lgkmcnt(8)
  v_mfma_f32_32x32x16_bf16 v[112:127], v[16:19], v[156:159], v[112:127]
  v_mov_b32 v6, 9
  ds_write_b32 v5, v6 offset:0
  ds_read_b64_tr_b16 v[16:17], v2 offset:24832
  ds_read_b64_tr_b16 v[18:19], v2 offset:25600
  s_waitcnt lgkmcnt(9)
  v_mfma_f32_32x32x16_bf16 v[32:47], v[20:23], v[160:163], v[32:47]
  ds_read_b64_tr_b16 v[20:21], v2 offset:24864
  ds_read_b64_tr_b16 v[22:23], v2 offset:25632
  s_waitcnt lgkmcnt(9)
  v_mfma_f32_32x32x16_bf16 v[48:63], v[24:27], v[160:163], v[48:63]
  ds_read_b64_tr_b16 v[24:25], v2 offset:27776
  ds_read_b64_tr_b16 v[26:27], v2 offset:28544
  s_waitcnt lgkmcnt(9)
  v_mfma_f32_32x32x16_bf16 v[64:79], v[8:11], v[160:163], v[64:79]
  ds_read_b64_tr_b16 v[8:9], v2 offset:27808
  ds_read_b64_tr_b16 v[10:11], v2 offset:28576
  s_waitcnt lgkmcnt(9)
  v_mfma_f32_32x32x16_bf16 v[80:95], v[12:15], v[160:163], v[80:95]
  s_waitcnt vmcnt(0)
  v_mov_b32 v6, 11
  ds_write_b32 v5, v6 offset:48
  ds_read_b64_tr_b16 v[12:13], v2 offset:27840
  ds_read_b64_tr_b16 v[14:15], v2 offset:28608
  s_waitcnt lgkmcnt(9)
  v_mfma_f32_32x32x16_bf16 v[96:111], v[16:19], v[160:163], v[96:111]
  ds_read_b64_tr_b16 v[16:17], v2 offset:27872
  ds_read_b64_tr_b16 v[18:19], v2 offset:28640
  s_waitcnt lgkmcnt(9)
  v_mfma_f32_32x32x16_bf16 v[112:127], v[20:23], v[160:163], v[112:127]
  ds_read_b64_tr_b16 v[20:21], v2 offset:27904
  ds_read_b64_tr_b16 v[22:23], v2 offset:28672
  s_waitcnt lgkmcnt(9)
  v_mfma_f32_32x32x16_bf16 v[32:47], v[24:27], v[164:167], v[32:47]
  ds_read_b64_tr_b16 v[24:25], v2 offset:27936
  ds_read_b64_tr_b16 v[26:27], v2 offset:28704
  s_waitcnt lgkmcnt(9)
  v_mfma_f32_32x32x16_bf16 v[48:63], v[8:11], v[164:167], v[48:63]
  ds_read_b64_tr_b16 v[8:9], v2 offset:30848
  ds_read_b64_tr_b16 v[10:11], v2 offset:31616
  s_waitcnt lgkmcnt(8)
  v_mfma_f32_32x32x16_bf16 v[64:79], v[12:15], v[164:167], v[64:79]
  ds_read_b64_tr_b16 v[12:13], v2 offset:30880
  ds_read_b64_tr_b16 v[14:15], v2 offset:31648
  s_waitcnt lgkmcnt(8)
  v_mfma_f32_32x32x16_bf16 v[80:95], v[16:19], v[164:167], v[80:95]
  ds_read_b64_tr_b16 v[16:17], v2 offset:30912
  ds_read_b64_tr_b16 v[18:19], v2 offset:31680
  s_waitcnt lgkmcnt(8)
  v_mfma_f32_32x32x16_bf16 v[96:111], v[20:23], v[164:167], v[96:111]
  ds_read_b64_tr_b16 v[20:21], v2 offset:30944
  ds_read_b64_tr_b16 v[22:23], v2 offset:31712
  s_waitcnt lgkmcnt(8)
  v_mfma_f32_32x32x16_bf16 v[112:127], v[24:27], v[164:167], v[112:127]
  ds_read_b64_tr_b16 v[24:25], v2 offset:30976
  ds_read_b64_tr_b16 v[26:27], v2 offset:31744
  s_waitcnt lgkmcnt(8)
  v_mfma_f32_32x32x16_bf16 v[32:47], v[8:11], v[168:171], v[32:47]
  ds_read_b128 v[28:31], v4 offset:64
  ds_read_b64_tr_b16 v[8:9], v2 offset:31008
  ds_read_b64_tr_b16 v[10:11], v2 offset:31776
  s_waitcnt lgkmcnt(9)
  v_mfma_f32_32x32x16_bf16 v[48:63], v[12:15], v[168:171], v[48:63]
  ds_read_b64_tr_b16 v[12:13], v2 offset:33920
  ds_read_b64_tr_b16 v[14:15], v2 offset:34688
  s_waitcnt lgkmcnt(9)
  v_mfma_f32_32x32x16_bf16 v[64:79], v[16:19], v[168:171], v[64:79]
  ds_read_b64_tr_b16 v[16:17], v2 offset:33952
  ds_read_b64_tr_b16 v[18:19], v2 offset:34720
  s_waitcnt lgkmcnt(9)
  v_mfma_f32_32x32x16_bf16 v[80:95], v[20:23], v[168:171], v[80:95]
  ds_read_b64_tr_b16 v[20:21], v2 offset:33984
  ds_read_b64_tr_b16 v[22:23], v2 offset:34752
  s_waitcnt lgkmcnt(9)
  v_mfma_f32_32x32x16_bf16 v[96:111], v[24:27], v[168:171], v[96:111]
  ds_read_b64_tr_b16 v[24:25], v2 offset:34016
  ds_read_b64_tr_b16 v[26:27], v2 offset:34784
  s_waitcnt lgkmcnt(8)
  v_mfma_f32_32x32x16_bf16 v[112:127], v[8:11], v[168:171], v[112:127]
  ds_read_b64_tr_b16 v[8:9], v2 offset:34048
  ds_read_b64_tr_b16 v[10:11], v2 offset:34816
  s_waitcnt lgkmcnt(8)
  v_mfma_f32_32x32x16_bf16 v[32:47], v[12:15], v[172:175], v[32:47]
  v_min3_u32 v28, v28, v29, v30
  v_min_u32 v28, v28, v31
  v_cmp_gt_u32 vcc, 11, v28
  ds_read_b64_tr_b16 v[12:13], v2 offset:34080
  ds_read_b64_tr_b16 v[14:15], v2 offset:34848
  s_waitcnt lgkmcnt(8)
  v_mfma_f32_32x32x16_bf16 v[48:63], v[16:19], v[172:175], v[48:63]
lsp_9b20_1005:
  s_nop 0
  s_cbranch_vccz lok_9b20_1006
  s_add_u32 s3, s3, 1
  s_cmp_gt_u32 s3, 4194304
  s_cbranch_scc1 lok_9b20_1006
  ds_read_b128 v[28:31], v4 offset:64
  s_waitcnt lgkmcnt(0)
  v_min3_u32 v28, v28, v29, v30
  v_min_u32 v28, v28, v31
  v_cmp_gt_u32 vcc, 11, v28
  s_nop 4
  s_branch lsp_9b20_1005
lok_9b20_1006:
  ds_read_b64_tr_b16 v[16:17], v1 offset:0
  ds_read_b64_tr_b16 v[18:19], v1 offset:768
  s_waitcnt lgkmcnt(8)
  v_mfma_f32_32x32x16_bf16 v[64:79], v[20:23], v[172:175], v[64:79]
  ds_read_b64_tr_b16 v[20:21], v1 offset:32
  ds_read_b64_tr_b16 v[22:23], v1 offset:800
  s_waitcnt lgkmcnt(8)
  v_mfma_f32_32x32x16_bf16 v[80:95], v[24:27], v[172:175], v[80:95]
  ds_read_b64_tr_b16 v[24:25], v1 offset:64
  ds_read_b64_tr_b16 v[26:27], v1 offset:832
  s_waitcnt lgkmcnt(8)
  v_mfma_f32_32x32x16_bf16 v[96:111], v[8:11], v[172:175], v[96:111]
  ds_read_b64_tr_b16 v[8:9], v1 offset:96
  ds_read_b64_tr_b16 v[10:11], v1 offset:864
  s_waitcnt lgkmcnt(8)
  v_mfma_f32_32x32x16_bf16 v[112:127], v[12:15], v[172:175], v[112:127]
  ds_read_b64_tr_b16 v[12:13], v1 offset:128
  ds_read_b64_tr_b16 v[14:15], v1 offset:896
  s_waitcnt lgkmcnt(8)
  v_mfma_f32_32x32x16_bf16 v[32:47], v[16:19], v[176:179], v[32:47]
  ds_read_b64_tr_b16 v[16:17], v1 offset:160
  ds_read_b64_tr_b16 v[18:19], v1 offset:928
  s_waitcnt lgkmcnt(8)
  v_mfma_f32_32x32x16_bf16 v[48:63], v[20:23], v[176:179], v[48:63]
  ds_read_b64_tr_b16 v[20:21], v1 offset:3072
  ds_read_b64_tr_b16 v[22:23], v1 offset:3840
  s_waitcnt lgkmcnt(8)
  v_mfma_f32_32x32x16_bf16 v[64:79], v[24:27], v[176:179], v[64:79]
  ds_read_b64_tr_b16 v[24:25], v1 offset:3104
  ds_read_b64_tr_b16 v[26:27], v1 offset:3872
  s_waitcnt lgkmcnt(8)
  v_mfma_f32_32x32x16_bf16 v[80:95], v[8:11], v[176:179], v[80:95]
  ds_read_b64_tr_b16 v[8:9], v1 offset:3136
  ds_read_b64_tr_b16 v[10:11], v1 offset:3904
  s_waitcnt lgkmcnt(8)
  v_mfma_f32_32x32x16_bf16 v[96:111], v[12:15], v[176:179], v[96:111]
  ds_read_b64_tr_b16 v[12:13], v1 offset:3168
  ds_read_b64_tr_b16 v[14:15], v1 offset:3936
  s_waitcnt lgkmcnt(8)
  v_mfma_f32_32x32x16_bf16 v[112:127], v[16:19], v[176:179], v[112:127]
  ds_read_b64_tr_b16 v[16:17], v1 offset:3200
  ds_read_b64_tr_b16 v[18:19], v1 offset:3968
  s_waitcnt lgkmcnt(8)
  v_mfma_f32_32x32x16_bf16 v[32:47], v[20:23], v[180:183], v[32:47]
  ds_read_b64_tr_b16 v[20:21], v1 offset:3232
  ds_read_b64_tr_b16 v[22:23], v1 offset:4000
  s_waitcnt lgkmcnt(8)
  v_mfma_f32_32x32x16_bf16 v[48:63], v[24:27], v[180:183], v[48:63]
  ds_read_b64_tr_b16 v[24:25], v1 offset:6144
  ds_read_b64_tr_b16 v[26:27], v1 offset:6912
  s_waitcnt lgkmcnt(8)
  v_mfma_f32_32x32x16_bf16 v[64:79], v[8:11], v[180:183], v[64:79]
  ds_read_b64_tr_b16 v[8:9], v1 offset:6176
  ds_read_b64_tr_b16 v[10:11], v1 offset:6944
  s_waitcnt lgkmcnt(8)
  v_mfma_f32_32x32x16_bf16 v[80:95], v[12:15], v[180:183], v[80:95]
  ds_read_b64_tr_b16 v[12:13], v1 offset:6208
  ds_read_b64_tr_b16 v[14:15], v1 offset:6976
  s_waitcnt lgkmcnt(8)
  v_mfma_f32_32x32x16_bf16 v[96:111], v[16:19], v[180:183], v[96:111]
  ds_read_b64_tr_b16 v[16:17], v1 offset:6240
  ds_read_b64_tr_b16 v[18:19], v1 offset:7008
  s_waitcnt lgkmcnt(8)
  v_mfma_f32_32x32x16_bf16 v[112:127], v[20:23], v[180:183], v[112:127]
  ds_read_b64_tr_b16 v[20:21], v1 offset:6272
  ds_read_b64_tr_b16 v[22:23], v1 offset:7040
  s_waitcnt lgkmcnt(8)
  v_mfma_f32_32x32x16_bf16 v[32:47], v[24:27], v[184:187], v[32:47]
  ds_read_b128 v[28:31], v4 offset:0
  ds_read_b64_tr_b16 v[24:25], v1 offset:6304
  ds_read_b64_tr_b16 v[26:27], v1 offset:7072
  s_waitcnt lgkmcnt(9)
  v_mfma_f32_32x32x16_bf16 v[48:63], v[8:11], v[184:187], v[48:63]
  ds_read_b64_tr_b16 v[8:9], v1 offset:9216
  ds_read_b64_tr_b16 v[10:11], v1 offset:9984
  s_waitcnt lgkmcnt(9)
  v_mfma_f32_32x32x16_bf16 v[64:79], v[12:15], v[184:187], v[64:79]
  ds_read_b64_tr_b16 v[12:13], v1 offset:9248
  ds_read_b64_tr_b16 v[14:15], v1 offset:10016
  s_waitcnt lgkmcnt(9)
  v_mfma_f32_32x32x16_bf16 v[80:95], v[16:19], v[184:187], v[80:95]
  ds_read_b64_tr_b16 v[16:17], v1 offset:9280
  ds_read_b64_tr_b16 v[18:19], v1 offset:10048
  s_waitcnt lgkmcnt(9)
  v_mfma_f32_32x32x16_bf16 v[96:111], v[20:23], v[184:187], v[96:111]
  ds_read_b64_tr_b16 v[20:21], v1 offset:9312
  ds_read_b64_tr_b16 v[22:23], v1 offset:10080
  s_waitcnt lgkmcnt(8)
  v_mfma_f32_32x32x16_bf16 v[112:127], v[24:27], v[184:187], v[112:127]
  ds_read_b64_tr_b16 v[24:25], v1 offset:9344
  ds_read_b64_tr_b16 v[26:27], v1 offset:10112
  s_waitcnt lgkmcnt(8)
  v_mfma_f32_32x32x16_bf16 v[32:47], v[8:11], v[188:191], v[32:47]
  v_min3_u32 v28, v28, v29, v30
  v_min_u32 v28, v28, v31
  v_cmp_gt_u32 vcc, 12, v28
  ds_read_b64_tr_b16 v[8:9], v1 offset:9376
  ds_read_b64_tr_b16 v[10:11], v1 offset:10144
  s_waitcnt lgkmcnt(8)
  v_mfma_f32_32x32x16_bf16 v[48:63], v[12:15], v[188:191], v[48:63]
lsp_9b20_1007:
  s_nop 0
  s_cbranch_vccz lok_9b20_1008
  s_add_u32 s3, s3, 1
  s_cmp_gt_u32 s3, 4194304
  s_cbranch_scc1 lok_9b20_1008
  ds_read_b128 v[28:31], v4 offset:0
  s_waitcnt lgkmcnt(0)
  v_min3_u32 v28, v28, v29, v30
  v_min_u32 v28, v28, v31
  v_cmp_gt_u32 vcc, 12, v28
  s_nop 4
  s_branch lsp_9b20_1007
lok_9b20_1008:
  ds_read_b64_tr_b16 v[12:13], v1 offset:24704
  ds_read_b64_tr_b16 v[14:15], v1 offset:25472
  s_waitcnt lgkmcnt(8)
  v_mfma_f32_32x32x16_bf16 v[64:79], v[16:19], v[188:191], v[64:79]
  ds_read_b64_tr_b16 v[16:17], v1 offset:24736
  ds_read_b64_tr_b16 v[18:19], v1 offset:25504
  s_waitcnt lgkmcnt(8)
  v_mfma_f32_32x32x16_bf16 v[80:95], v[20:23], v[188:191], v[80:95]
  ds_read_b64_tr_b16 v[20:21], v1 offset:24768
  ds_read_b64_tr_b16 v[22:23], v1 offset:25536
  s_waitcnt lgkmcnt(8)
  v_mfma_f32_32x32x16_bf16 v[96:111], v[24:27], v[188:191], v[96:111]
  ds_read_b64_tr_b16 v[24:25], v1 offset:24800
  ds_read_b64_tr_b16 v[26:27], v1 offset:25568
  s_waitcnt lgkmcnt(8)
  v_mfma_f32_32x32x16_bf16 v[112:127], v[8:11], v[188:191], v[112:127]
  ds_read_b64_tr_b16 v[8:9], v1 offset:24832
  ds_read_b64_tr_b16 v[10:11], v1 offset:25600
  s_waitcnt lgkmcnt(8)
  v_mfma_f32_32x32x16_bf16 v[32:47], v[12:15], v[192:195], v[32:47]
  ds_read_b64_tr_b16 v[12:13], v1 offset:24864
  ds_read_b64_tr_b16 v[14:15], v1 offset:25632
  s_waitcnt lgkmcnt(8)
  v_mfma_f32_32x32x16_bf16 v[48:63], v[16:19], v[192:195], v[48:63]
  ds_read_b64_tr_b16 v[16:17], v1 offset:27776
  ds_read_b64_tr_b16 v[18:19], v1 offset:28544
  s_waitcnt lgkmcnt(8)
  v_mfma_f32_32x32x16_bf16 v[64:79], v[20:23], v[192:195], v[64:79]
  ds_read_b64_tr_b16 v[20:21], v1 offset:27808
  ds_read_b64_tr_b16 v[22:23], v1 offset:28576
  s_waitcnt lgkmcnt(8)
  v_mfma_f32_32x32x16_bf16 v[80:95], v[24:27], v[192:195], v[80:95]
  ds_read_b64_tr_b16 v[24:25], v1 offset:27840
  ds_read_b64_tr_b16 v[26:27], v1 offset:28608
  s_waitcnt lgkmcnt(8)
  v_mfma_f32_32x32x16_bf16 v[96:111], v[8:11], v[192:195], v[96:111]
  ds_read_b64_tr_b16 v[8:9], v1 offset:27872
  ds_read_b64_tr_b16 v[10:11], v1 offset:28640
  s_waitcnt lgkmcnt(8)
  v_mfma_f32_32x32x16_bf16 v[112:127], v[12:15], v[192:195], v[112:127]
  ds_read_b64_tr_b16 v[12:13], v1 offset:27904
  ds_read_b64_tr_b16 v[14:15], v1 offset:28672
  s_waitcnt lgkmcnt(8)
  v_mfma_f32_32x32x16_bf16 v[32:47], v[16:19], v[196:199], v[32:47]
  ds_read_b64_tr_b16 v[16:17], v1 offset:27936
  ds_read_b64_tr_b16 v[18:19], v1 offset:28704
  s_waitcnt lgkmcnt(8)
  v_mfma_f32_32x32x16_bf16 v[48:63], v[20:23], v[196:199], v[48:63]
  ds_read_b64_tr_b16 v[20:21], v1 offset:30848
  ds_read_b64_tr_b16 v[22:23], v1 offset:31616
  s_waitcnt lgkmcnt(8)
  v_mfma_f32_32x32x16_bf16 v[64:79], v[24:27], v[196:199], v[64:79]
  ds_read_b64_tr_b16 v[24:25], v1 offset:30880
  ds_read_b64_tr_b16 v[26:27], v1 offset:31648
  s_waitcnt lgkmcnt(8)
  v_mfma_f32_32x32x16_bf16 v[80:95], v[8:11], v[196:199], v[80:95]
  ds_read_b64_tr_b16 v[8:9], v1 offset:30912
  ds_read_b64_tr_b16 v[10:11], v1 offset:31680
  s_waitcnt lgkmcnt(8)
  v_mfma_f32_32x32x16_bf16 v[96:111], v[12:15], v[196:199], v[96:111]
  ds_read_b64_tr_b16 v[12:13], v1 offset:30944
  ds_read_b64_tr_b16 v[14:15], v1 offset:31712
  s_waitcnt lgkmcnt(8)
  v_mfma_f32_32x32x16_bf16 v[112:127], v[16:19], v[196:199], v[112:127]
  ds_read_b64_tr_b16 v[16:17], v1 offset:30976
  ds_read_b64_tr_b16 v[18:19], v1 offset:31744
  s_waitcnt lgkmcnt(8)
  v_mfma_f32_32x32x16_bf16 v[32:47], v[20:23], v[200:203], v[32:47]
  ds_read_b128 v[28:31], v4 offset:0
  ds_read_b64_tr_b16 v[20:21], v1 offset:31008
  ds_read_b64_tr_b16 v[22:23], v1 offset:31776
  s_waitcnt lgkmcnt(9)
  v_mfma_f32_32x32x16_bf16 v[48:63], v[24:27], v[200:203], v[48:63]
  ds_read_b64_tr_b16 v[24:25], v1 offset:33920
  ds_read_b64_tr_b16 v[26:27], v1 offset:34688
  s_waitcnt lgkmcnt(9)
  v_mfma_f32_32x32x16_bf16 v[64:79], v[8:11], v[200:203], v[64:79]
  ds_read_b64_tr_b16 v[8:9], v1 offset:33952
  ds_read_b64_tr_b16 v[10:11], v1 offset:34720
  s_waitcnt lgkmcnt(9)
  v_mfma_f32_32x32x16_bf16 v[80:95], v[12:15], v[200:203], v[80:95]
  ds_read_b64_tr_b16 v[12:13], v1 offset:33984
  ds_read_b64_tr_b16 v[14:15], v1 offset:34752
  s_waitcnt lgkmcnt(9)
  v_mfma_f32_32x32x16_bf16 v[96:111], v[16:19], v[200:203], v[96:111]
  ds_read_b64_tr_b16 v[16:17], v1 offset:34016
  ds_read_b64_tr_b16 v[18:19], v1 offset:34784
  s_waitcnt lgkmcnt(8)
  v_mfma_f32_32x32x16_bf16 v[112:127], v[20:23], v[200:203], v[112:127]
  ds_read_b64_tr_b16 v[20:21], v1 offset:34048
  ds_read_b64_tr_b16 v[22:23], v1 offset:34816
  s_waitcnt lgkmcnt(8)
  v_mfma_f32_32x32x16_bf16 v[32:47], v[24:27], v[204:207], v[32:47]
  v_min3_u32 v28, v28, v29, v30
  v_min_u32 v28, v28, v31
  v_cmp_gt_u32 vcc, 13, v28
  ds_read_b64_tr_b16 v[24:25], v1 offset:34080
  ds_read_b64_tr_b16 v[26:27], v1 offset:34848
  s_waitcnt lgkmcnt(8)
  v_mfma_f32_32x32x16_bf16 v[48:63], v[8:11], v[204:207], v[48:63]
lsp_9b20_1009:
  s_nop 0
  s_cbranch_vccz lok_9b20_1010
  s_add_u32 s3, s3, 1
  s_cmp_gt_u32 s3, 4194304
  s_cbranch_scc1 lok_9b20_1010
  ds_read_b128 v[28:31], v4 offset:0
  s_waitcnt lgkmcnt(0)
  v_min3_u32 v28, v28, v29, v30
  v_min_u32 v28, v28, v31
  v_cmp_gt_u32 vcc, 13, v28
  s_nop 4
  s_branch lsp_9b20_1009
lok_9b20_1010:
  ds_read_b64_tr_b16 v[8:9], v2 offset:0
  ds_read_b64_tr_b16 v[10:11], v2 offset:768
  s_waitcnt lgkmcnt(8)
  v_mfma_f32_32x32x16_bf16 v[64:79], v[12:15], v[204:207], v[64:79]
  ds_read_b64_tr_b16 v[12:13], v2 offset:32
  ds_read_b64_tr_b16 v[14:15], v2 offset:800
  s_waitcnt lgkmcnt(8)
  v_mfma_f32_32x32x16_bf16 v[80:95], v[16:19], v[204:207], v[80:95]
  ds_read_b64_tr_b16 v[16:17], v2 offset:64
  ds_read_b64_tr_b16 v[18:19], v2 offset:832
  s_waitcnt lgkmcnt(8)
  v_mfma_f32_32x32x16_bf16 v[96:111], v[20:23], v[204:207], v[96:111]
  ds_read_b64_tr_b16 v[20:21], v2 offset:96
  ds_read_b64_tr_b16 v[22:23], v2 offset:864
  s_waitcnt lgkmcnt(8)
  v_mfma_f32_32x32x16_bf16 v[112:127], v[24:27], v[204:207], v[112:127]
  ds_read_b64_tr_b16 v[24:25], v2 offset:128
  ds_read_b64_tr_b16 v[26:27], v2 offset:896
  s_waitcnt lgkmcnt(8)
  v_mfma_f32_32x32x16_bf16 v[32:47], v[8:11], v[208:211], v[32:47]
  ds_read_b64_tr_b16 v[8:9], v2 offset:160
  ds_read_b64_tr_b16 v[10:11], v2 offset:928
  s_waitcnt lgkmcnt(8)
  v_mfma_f32_32x32x16_bf16 v[48:63], v[12:15], v[208:211], v[48:63]
  ds_read_b64_tr_b16 v[12:13], v2 offset:3072
  ds_read_b64_tr_b16 v[14:15], v2 offset:3840
  s_waitcnt lgkmcnt(8)
  v_mfma_f32_32x32x16_bf16 v[64:79], v[16:19], v[208:211], v[64:79]
  ds_read_b64_tr_b16 v[16:17], v2 offset:3104
  ds_read_b64_tr_b16 v[18:19], v2 offset:3872
  s_waitcnt lgkmcnt(8)
  v_mfma_f32_32x32x16_bf16 v[80:95], v[20:23], v[208:211], v[80:95]
  ds_read_b64_tr_b16 v[20:21], v2 offset:3136
  ds_read_b64_tr_b16 v[22:23], v2 offset:3904
  s_waitcnt lgkmcnt(8)
  v_mfma_f32_32x32x16_bf16 v[96:111], v[24:27], v[208:211], v[96:111]
  ds_read_b64_tr_b16 v[24:25], v2 offset:3168
  ds_read_b64_tr_b16 v[26:27], v2 offset:3936
  s_waitcnt lgkmcnt(8)
  v_mfma_f32_32x32x16_bf16 v[112:127], v[8:11], v[208:211], v[112:127]
  ds_read_b64_tr_b16 v[8:9], v2 offset:3200
  ds_read_b64_tr_b16 v[10:11], v2 offset:3968
  s_waitcnt lgkmcnt(8)
  v_mfma_f32_32x32x16_bf16 v[32:47], v[12:15], v[212:215], v[32:47]
  ds_read_b64_tr_b16 v[12:13], v2 offset:3232
  ds_read_b64_tr_b16 v[14:15], v2 offset:4000
  s_waitcnt lgkmcnt(8)
  v_mfma_f32_32x32x16_bf16 v[48:63], v[16:19], v[212:215], v[48:63]
  ds_read_b64_tr_b16 v[16:17], v2 offset:6144
  ds_read_b64_tr_b16 v[18:19], v2 offset:6912
  s_waitcnt lgkmcnt(8)
  v_mfma_f32_32x32x16_bf16 v[64:79], v[20:23], v[212:215], v[64:79]
  ds_read_b64_tr_b16 v[20:21], v2 offset:6176
  ds_read_b64_tr_b16 v[22:23], v2 offset:6944
  s_waitcnt lgkmcnt(8)
  v_mfma_f32_32x32x16_bf16 v[80:95], v[24:27], v[212:215], v[80:95]
  ds_read_b64_tr_b16 v[24:25], v2 offset:6208
  ds_read_b64_tr_b16 v[26:27], v2 offset:6976
  s_waitcnt lgkmcnt(8)
  v_mfma_f32_32x32x16_bf16 v[96:111], v[8:11], v[212:215], v[96:111]
  ds_read_b64_tr_b16 v[8:9], v2 offset:6240
  ds_read_b64_tr_b16 v[10:11], v2 offset:7008
  s_waitcnt lgkmcnt(8)
  v_mfma_f32_32x32x16_bf16 v[112:127], v[12:15], v[212:215], v[112:127]
  ds_read_b64_tr_b16 v[12:13], v2 offset:6272
  ds_read_b64_tr_b16 v[14:15], v2 offset:7040
  s_waitcnt lgkmcnt(8)
  v_mfma_f32_32x32x16_bf16 v[32:47], v[16:19], v[216:219], v[32:47]
  ds_read_b128 v[28:31], v4 offset:0
  ds_read_b64_tr_b16 v[16:17], v2 offset:6304
  ds_read_b64_tr_b16 v[18:19], v2 offset:7072
  s_waitcnt lgkmcnt(9)
  v_mfma_f32_32x32x16_bf16 v[48:63], v[20:23], v[216:219], v[48:63]
  ds_read_b64_tr_b16 v[20:21], v2 offset:9216
  ds_read_b64_tr_b16 v[22:23], v2 offset:9984
  s_waitcnt lgkmcnt(9)
  v_mfma_f32_32x32x16_bf16 v[64:79], v[24:27], v[216:219], v[64:79]
  ds_read_b64_tr_b16 v[24:25], v2 offset:9248
  ds_read_b64_tr_b16 v[26:27], v2 offset:10016
  s_waitcnt lgkmcnt(9)
  v_mfma_f32_32x32x16_bf16 v[80:95], v[8:11], v[216:219], v[80:95]
  ds_read_b64_tr_b16 v[8:9], v2 offset:9280
  ds_read_b64_tr_b16 v[10:11], v2 offset:10048
  s_waitcnt lgkmcnt(9)
  v_mfma_f32_32x32x16_bf16 v[96:111], v[12:15], v[216:219], v[96:111]
  ds_read_b64_tr_b16 v[12:13], v2 offset:9312
  ds_read_b64_tr_b16 v[14:15], v2 offset:10080
  s_waitcnt lgkmcnt(8)
  v_mfma_f32_32x32x16_bf16 v[112:127], v[16:19], v[216:219], v[112:127]
  ds_read_b64_tr_b16 v[16:17], v2 offset:9344
  ds_read_b64_tr_b16 v[18:19], v2 offset:10112
  s_waitcnt lgkmcnt(8)
  v_mfma_f32_32x32x16_bf16 v[32:47], v[20:23], v[220:223], v[32:47]
  v_min3_u32 v28, v28, v29, v30
  v_min_u32 v28, v28, v31
  v_cmp_gt_u32 vcc, 14, v28
  ds_read_b64_tr_b16 v[20:21], v2 offset:9376
  ds_read_b64_tr_b16 v[22:23], v2 offset:10144
  s_waitcnt lgkmcnt(8)
  v_mfma_f32_32x32x16_bf16 v[48:63], v[24:27], v[220:223], v[48:63]
lsp_9b20_1011:
  s_nop 0
  s_cbranch_vccz lok_9b20_1012
  s_add_u32 s3, s3, 1
  s_cmp_gt_u32 s3, 4194304
  s_cbranch_scc1 lok_9b20_1012
  ds_read_b128 v[28:31], v4 offset:0
  s_waitcnt lgkmcnt(0)
  v_min3_u32 v28, v28, v29, v30
  v_min_u32 v28, v28, v31
  v_cmp_gt_u32 vcc, 14, v28
  s_nop 4
  s_branch lsp_9b20_1011
lok_9b20_1012:
  ds_read_b64_tr_b16 v[24:25], v3 offset:0
  ds_read_b64_tr_b16 v[26:27], v3 offset:768
  s_waitcnt lgkmcnt(8)
  v_mfma_f32_32x32x16_bf16 v[64:79], v[8:11], v[220:223], v[64:79]
  ds_read_b64_tr_b16 v[8:9], v3 offset:32
  ds_read_b64_tr_b16 v[10:11], v3 offset:800
  s_waitcnt lgkmcnt(8)
  v_mfma_f32_32x32x16_bf16 v[80:95], v[12:15], v[220:223], v[80:95]
  ds_read_b64_tr_b16 v[12:13], v3 offset:64
  ds_read_b64_tr_b16 v[14:15], v3 offset:832
  s_waitcnt lgkmcnt(8)
  v_mfma_f32_32x32x16_bf16 v[96:111], v[16:19], v[220:223], v[96:111]
  ds_read_b64_tr_b16 v[16:17], v3 offset:96
  ds_read_b64_tr_b16 v[18:19], v3 offset:864
  s_waitcnt lgkmcnt(8)
  v_mfma_f32_32x32x16_bf16 v[112:127], v[20:23], v[220:223], v[112:127]
  ds_read_b64_tr_b16 v[20:21], v3 offset:128
  ds_read_b64_tr_b16 v[22:23], v3 offset:896
  s_waitcnt lgkmcnt(8)
  v_mfma_f32_32x32x16_bf16 v[32:47], v[24:27], v[224:227], v[32:47]
  ds_read_b64_tr_b16 v[24:25], v3 offset:160
  ds_read_b64_tr_b16 v[26:27], v3 offset:928
  s_waitcnt lgkmcnt(8)
  v_mfma_f32_32x32x16_bf16 v[48:63], v[8:11], v[224:227], v[48:63]
  ds_read_b64_tr_b16 v[8:9], v3 offset:3072
  ds_read_b64_tr_b16 v[10:11], v3 offset:3840
  s_waitcnt lgkmcnt(8)
  v_mfma_f32_32x32x16_bf16 v[64:79], v[12:15], v[224:227], v[64:79]
  ds_read_b64_tr_b16 v[12:13], v3 offset:3104
  ds_read_b64_tr_b16 v[14:15], v3 offset:3872
  s_waitcnt lgkmcnt(8)
  v_mfma_f32_32x32x16_bf16 v[80:95], v[16:19], v[224:227], v[80:95]
  ds_read_b64_tr_b16 v[16:17], v3 offset:3136
  ds_read_b64_tr_b16 v[18:19], v3 offset:3904
  s_waitcnt lgkmcnt(8)
  v_mfma_f32_32x32x16_bf16 v[96:111], v[20:23], v[224:227], v[96:111]
  ds_read_b64_tr_b16 v[20:21], v3 offset:3168
  ds_read_b64_tr_b16 v[22:23], v3 offset:3936
  s_waitcnt lgkmcnt(8)
  v_mfma_f32_32x32x16_bf16 v[112:127], v[24:27], v[224:227], v[112:127]
  ds_read_b64_tr_b16 v[24:25], v3 offset:3200
  ds_read_b64_tr_b16 v[26:27], v3 offset:3968
  s_waitcnt lgkmcnt(8)
  v_mfma_f32_32x32x16_bf16 v[32:47], v[8:11], v[228:231], v[32:47]
  ds_read_b64_tr_b16 v[8:9], v3 offset:3232
  ds_read_b64_tr_b16 v[10:11], v3 offset:4000
  s_waitcnt lgkmcnt(8)
  v_mfma_f32_32x32x16_bf16 v[48:63], v[12:15], v[228:231], v[48:63]
  ds_read_b64_tr_b16 v[12:13], v3 offset:6144
  ds_read_b64_tr_b16 v[14:15], v3 offset:6912
  s_waitcnt lgkmcnt(8)
  v_mfma_f32_32x32x16_bf16 v[64:79], v[16:19], v[228:231], v[64:79]
  ds_read_b64_tr_b16 v[16:17], v3 offset:6176
  ds_read_b64_tr_b16 v[18:19], v3 offset:6944
  s_waitcnt lgkmcnt(8)
  v_mfma_f32_32x32x16_bf16 v[80:95], v[20:23], v[228:231], v[80:95]
  ds_read_b64_tr_b16 v[20:21], v3 offset:6208
  ds_read_b64_tr_b16 v[22:23], v3 offset:6976
  s_waitcnt lgkmcnt(8)
  v_mfma_f32_32x32x16_bf16 v[96:111], v[24:27], v[228:231], v[96:111]
  ds_read_b64_tr_b16 v[24:25], v3 offset:6240
  ds_read_b64_tr_b16 v[26:27], v3 offset:7008
  s_waitcnt lgkmcnt(8)
  v_mfma_f32_32x32x16_bf16 v[112:127], v[8:11], v[228:231], v[112:127]
  ds_read_b64_tr_b16 v[8:9], v3 offset:6272
  ds_read_b64_tr_b16 v[10:11], v3 offset:7040
  s_waitcnt lgkmcnt(8)
  v_mfma_f32_32x32x16_bf16 v[32:47], v[12:15], v[232:235], v[32:47]
  v_and_b32 v132, 31, v0
  s_lshl_b32 s42, s37, 8
  s_add_u32 s42, s42, 161280
  v_lshl_add_u32 v132, v132, 3, s42
  ds_read_b64 v[128:129], v132 offset:0
  v_lshrrev_b32 v130, 5, v0
  v_lshlrev_b32 v130, 4, v130
  ds_read_b128 v[28:31], v4 offset:0
  ds_read_b64_tr_b16 v[12:13], v3 offset:6304
  ds_read_b64_tr_b16 v[14:15], v3 offset:7072
  s_waitcnt lgkmcnt(10)
  v_mfma_f32_32x32x16_bf16 v[48:63], v[16:19], v[232:235], v[48:63]
  v_add_u32 v130, 160128, v130
  v_lshlrev_b32 v131, 4, v0
  ds_read_b128 v[136:139], v130 offset:0
  ds_read_b128 v[140:143], v130 offset:64
  s_lshl_b32 s42, s39, 1
  s_lshr_b32 s43, s37, 1
  s_add_u32 s42, s42, s43
  s_mul_i32 s49, s42, 176128
  ds_read_b64_tr_b16 v[16:17], v3 offset:9216
  ds_read_b64_tr_b16 v[18:19], v3 offset:9984
  s_waitcnt lgkmcnt(12)
  v_mfma_f32_32x32x16_bf16 v[64:79], v[20:23], v[232:235], v[64:79]
  s_and_b32 s43, s37, 1
  s_lshl_b32 s43, s43, 10
  s_add_u32 s49, s49, s43
  s_lshl_b32 s43, s63, 11
  s_add_u32 s49, s49, s43
  s_add_u32 s49, s49, 6291456
  s_cmp_lt_u32 s40, 15
  s_cselect_b32 s49, s49, 0x40000000
  ds_read_b64_tr_b16 v[20:21], v3 offset:9248
  ds_read_b64_tr_b16 v[22:23], v3 offset:10016
  s_waitcnt lgkmcnt(12)
  v_mfma_f32_32x32x16_bf16 v[80:95], v[24:27], v[232:235], v[80:95]
  s_waitcnt lgkmcnt(9)
  v_mul_f32 v129, v129, v129
  ds_read_b64_tr_b16 v[24:25], v3 offset:9280
  ds_read_b64_tr_b16 v[26:27], v3 offset:10048
  v_mfma_f32_32x32x16_bf16 v[96:111], v[8:11], v[232:235], v[96:111]
  ds_read_b64_tr_b16 v[8:9], v3 offset:9312
  ds_read_b64_tr_b16 v[10:11], v3 offset:10080
  s_waitcnt lgkmcnt(10)
  v_mfma_f32_32x32x16_bf16 v[112:127], v[12:15], v[232:235], v[112:127]
  ds_read_b64_tr_b16 v[12:13], v3 offset:9344
  ds_read_b64_tr_b16 v[14:15], v3 offset:10112
  s_waitcnt lgkmcnt(8)
  v_mfma_f32_32x32x16_bf16 v[32:47], v[16:19], v[236:239], v[32:47]
  v_min3_u32 v28, v28, v29, v30
  v_min_u32 v28, v28, v31
  v_cmp_gt_u32 vcc, 15, v28
  ds_read_b64_tr_b16 v[16:17], v3 offset:9376
  ds_read_b64_tr_b16 v[18:19], v3 offset:10144
  s_waitcnt lgkmcnt(8)
  v_mfma_f32_32x32x16_bf16 v[48:63], v[20:23], v[236:239], v[48:63]
lsp_9b20_1013:
  s_nop 0
  s_cbranch_vccz lok_9b20_1014
  s_add_u32 s3, s3, 1
  s_cmp_gt_u32 s3, 4194304
  s_cbranch_scc1 lok_9b20_1014
  ds_read_b128 v[28:31], v4 offset:0
  s_waitcnt lgkmcnt(0)
  v_min3_u32 v28, v28, v29, v30
  v_min_u32 v28, v28, v31
  v_cmp_gt_u32 vcc, 15, v28
  s_nop 4
  s_branch lsp_9b20_1013
lok_9b20_1014:
  ds_read_b64_tr_b16 v[20:21], v3 offset:24704
  ds_read_b64_tr_b16 v[22:23], v3 offset:25472
  s_waitcnt lgkmcnt(8)
  v_mfma_f32_32x32x16_bf16 v[64:79], v[24:27], v[236:239], v[64:79]
  ds_read_b64_tr_b16 v[24:25], v3 offset:27776
  ds_read_b64_tr_b16 v[26:27], v3 offset:28544
  s_waitcnt lgkmcnt(8)
  v_mfma_f32_32x32x16_bf16 v[80:95], v[8:11], v[236:239], v[80:95]
  ds_read_b64_tr_b16 v[8:9], v3 offset:30848
  ds_read_b64_tr_b16 v[10:11], v3 offset:31616
  s_waitcnt lgkmcnt(8)
  v_mfma_f32_32x32x16_bf16 v[96:111], v[12:15], v[236:239], v[96:111]
  ds_read_b64_tr_b16 v[12:13], v3 offset:33920
  ds_read_b64_tr_b16 v[14:15], v3 offset:34688
  s_waitcnt lgkmcnt(8)
  v_mfma_f32_32x32x16_bf16 v[112:127], v[16:19], v[236:239], v[112:127]
  ds_read_b64_tr_b16 v[16:17], v3 offset:24736
  ds_read_b64_tr_b16 v[18:19], v3 offset:25504
  s_waitcnt lgkmcnt(8)
  v_mfma_f32_32x32x16_bf16 v[32:47], v[20:23], v[240:243], v[32:47]
  ds_read_b64_tr_b16 v[20:21], v3 offset:27808
  ds_read_b64_tr_b16 v[22:23], v3 offset:28576
  s_waitcnt lgkmcnt(8)
  v_mfma_f32_32x32x16_bf16 v[32:47], v[24:27], v[244:247], v[32:47]
  ds_read_b64_tr_b16 v[24:25], v3 offset:30880
  ds_read_b64_tr_b16 v[26:27], v3 offset:31648
  s_waitcnt lgkmcnt(8)
  v_mfma_f32_32x32x16_bf16 v[32:47], v[8:11], v[248:251], v[32:47]
  ds_read_b64_tr_b16 v[8:9], v3 offset:33952
  ds_read_b64_tr_b16 v[10:11], v3 offset:34720
  s_waitcnt lgkmcnt(8)
  v_mfma_f32_32x32x16_bf16 v[32:47], v[12:15], v[252:255], v[32:47]
  ds_read_b64_tr_b16 v[12:13], v3 offset:24768
  ds_read_b64_tr_b16 v[14:15], v3 offset:25536
  s_waitcnt lgkmcnt(8)
  v_mfma_f32_32x32x16_bf16 v[48:63], v[16:19], v[240:243], v[48:63]
  ds_read_b64_tr_b16 v[16:17], v3 offset:27840
  ds_read_b64_tr_b16 v[18:19], v3 offset:28608
  s_waitcnt lgkmcnt(8)
  v_mfma_f32_32x32x16_bf16 v[48:63], v[20:23], v[244:247], v[48:63]
  ds_read_b128 v[144:147], v130 offset:32
  ds_read_b128 v[148:151], v130 offset:96
  s_nop 3
  v_fmac_f32 v32, v128, v136
  v_fmac_f32 v33, v128, v137
  v_fmac_f32 v34, v128, v138
  v_fmac_f32 v35, v128, v139
  v_fmac_f32 v40, v128, v140
  ds_read_b64_tr_b16 v[20:21], v3 offset:30912
  ds_read_b64_tr_b16 v[22:23], v3 offset:31680
  s_waitcnt lgkmcnt(10)
  v_mfma_f32_32x32x16_bf16 v[48:63], v[24:27], v[248:251], v[48:63]
  v_fmac_f32 v41, v128, v141
  v_fmac_f32 v42, v128, v142
  v_fmac_f32 v43, v128, v143
  v_max_f32 v32, 0, v32
  v_max_f32 v33, 0, v33
  v_max_f32 v34, 0, v34
  v_max_f32 v35, 0, v35
  ds_read_b64_tr_b16 v[24:25], v3 offset:33984
  ds_read_b64_tr_b16 v[26:27], v3 offset:34752
  s_waitcnt lgkmcnt(10)
  v_mfma_f32_32x32x16_bf16 v[48:63], v[8:11], v[252:255], v[48:63]
  v_mul_f32 v40, v129, v40
  v_mul_f32 v41, v129, v41
  v_mul_f32 v42, v129, v42
  v_mul_f32 v43, v129, v43
  v_mul_f32 v32, v32, v40
  v_mul_f32 v33, v33, v41
  v_mul_f32 v34, v34, v42
  ds_read_b64_tr_b16 v[8:9], v3 offset:24800
  ds_read_b64_tr_b16 v[10:11], v3 offset:25568
  s_waitcnt lgkmcnt(10)
  v_mfma_f32_32x32x16_bf16 v[64:79], v[12:15], v[240:243], v[64:79]
  v_mul_f32 v35, v35, v43
  ds_read_b128 v[136:139], v130 offset:128
  ds_read_b128 v[140:143], v130 offset:192
  s_waitcnt lgkmcnt(8)
  v_fmac_f32 v36, v128, v144
  v_fmac_f32 v37, v128, v145
  v_fmac_f32 v38, v128, v146
  v_fmac_f32 v39, v128, v147
  ds_read_b64_tr_b16 v[12:13], v3 offset:27872
  ds_read_b64_tr_b16 v[14:15], v3 offset:28640
  v_mfma_f32_32x32x16_bf16 v[64:79], v[16:19], v[244:247], v[64:79]
  v_fmac_f32 v44, v128, v148
  v_fmac_f32 v45, v128, v149
  v_fmac_f32 v46, v128, v150
  v_fmac_f32 v47, v128, v151
  v_max_f32 v36, 0, v36
  v_max_f32 v37, 0, v37
  v_max_f32 v38, 0, v38
  ds_read_b64_tr_b16 v[16:17], v3 offset:30944
  ds_read_b64_tr_b16 v[18:19], v3 offset:31712
  s_waitcnt lgkmcnt(10)
  v_mfma_f32_32x32x16_bf16 v[64:79], v[20:23], v[248:251], v[64:79]
  v_max_f32 v39, 0, v39
  v_mul_f32 v44, v129, v44
  v_mul_f32 v45, v129, v45
  v_mul_f32 v46, v129, v46
  v_mul_f32 v47, v129, v47
  v_mul_f32 v36, v36, v44
  v_mul_f32 v37, v37, v45
  ds_read_b64_tr_b16 v[20:21], v3 offset:34016
  ds_read_b64_tr_b16 v[22:23], v3 offset:34784
  s_waitcnt lgkmcnt(10)
  v_mfma_f32_32x32x16_bf16 v[64:79], v[24:27], v[252:255], v[64:79]
  v_mul_f32 v38, v38, v46
  v_mul_f32 v39, v39, v47
  v_cvt_pk_bf16_f32 v32, v32, v33
  v_cvt_pk_bf16_f32 v33, v34, v35
  v_cvt_pk_bf16_f32 v34, v36, v37
  v_cvt_pk_bf16_f32 v35, v38, v39
  s_add_u32 s42, s49, 0
  buffer_store_dwordx4 v[32:35], v131, s[32:35], s42 offen sc1
  ds_read_b64_tr_b16 v[24:25], v3 offset:24832
  ds_read_b64_tr_b16 v[26:27], v3 offset:25600
  s_waitcnt lgkmcnt(10)
  v_mfma_f32_32x32x16_bf16 v[80:95], v[8:11], v[240:243], v[80:95]
  ds_read_b128 v[144:147], v130 offset:160
  ds_read_b128 v[148:151], v130 offset:224
  s_waitcnt lgkmcnt(10)
  v_fmac_f32 v48, v128, v136
  v_fmac_f32 v49, v128, v137
  v_fmac_f32 v50, v128, v138
  v_fmac_f32 v51, v128, v139
  v_fmac_f32 v56, v128, v140
  ds_read_b64_tr_b16 v[8:9], v3 offset:27904
  ds_read_b64_tr_b16 v[10:11], v3 offset:28672
  s_waitcnt lgkmcnt(10)
  v_mfma_f32_32x32x16_bf16 v[80:95], v[12:15], v[244:247], v[80:95]
  v_fmac_f32 v57, v128, v141
  v_fmac_f32 v58, v128, v142
  v_fmac_f32 v59, v128, v143
  v_max_f32 v48, 0, v48
  v_max_f32 v49, 0, v49
  v_max_f32 v50, 0, v50
  v_max_f32 v51, 0, v51
  ds_read_b64_tr_b16 v[12:13], v3 offset:30976
  ds_read_b64_tr_b16 v[14:15], v3 offset:31744
  s_waitcnt lgkmcnt(10)
  v_mfma_f32_32x32x16_bf16 v[80:95], v[16:19], v[248:251], v[80:95]
  v_mul_f32 v56, v129, v56
  v_mul_f32 v57, v129, v57
  v_mul_f32 v58, v129, v58
  v_mul_f32 v59, v129, v59
  v_mul_f32 v48, v48, v56
  v_mul_f32 v49, v49, v57
  v_mul_f32 v50, v50, v58
  ds_read_b64_tr_b16 v[16:17], v3 offset:34048
  ds_read_b64_tr_b16 v[18:19], v3 offset:34816
  s_waitcnt lgkmcnt(10)
  v_mfma_f32_32x32x16_bf16 v[80:95], v[20:23], v[252:255], v[80:95]
  v_mul_f32 v51, v51, v59
  ds_read_b128 v[136:139], v130 offset:256
  ds_read_b128 v[140:143], v130 offset:320
  s_waitcnt lgkmcnt(8)
  v_fmac_f32 v52, v128, v144
  v_fmac_f32 v53, v128, v145
  v_fmac_f32 v54, v128, v146
  v_fmac_f32 v55, v128, v147
  ds_read_b64_tr_b16 v[20:21], v3 offset:24864
  ds_read_b64_tr_b16 v[22:23], v3 offset:25632
  v_mfma_f32_32x32x16_bf16 v[96:111], v[24:27], v[240:243], v[96:111]
  v_fmac_f32 v60, v128, v148
  v_fmac_f32 v61, v128, v149
  v_fmac_f32 v62, v128, v150
  v_fmac_f32 v63, v128, v151
  v_max_f32 v52, 0, v52
  v_max_f32 v53, 0, v53
  v_max_f32 v54, 0, v54
  ds_read_b64_tr_b16 v[24:25], v3 offset:27936
  ds_read_b64_tr_b16 v[26:27], v3 offset:28704
  s_waitcnt lgkmcnt(10)
  v_mfma_f32_32x32x16_bf16 v[96:111], v[8:11], v[244:247], v[96:111]
  v_max_f32 v55, 0, v55
  v_mul_f32 v60, v129, v60
  v_mul_f32 v61, v129, v61
  v_mul_f32 v62, v129, v62
  v_mul_f32 v63, v129, v63
  v_mul_f32 v52, v52, v60
  v_mul_f32 v53, v53, v61
  ds_read_b64_tr_b16 v[8:9], v3 offset:31008
  ds_read_b64_tr_b16 v[10:11], v3 offset:31776
  s_waitcnt lgkmcnt(10)
  v_mfma_f32_32x32x16_bf16 v[96:111], v[12:15], v[248:251], v[96:111]
  v_mul_f32 v54, v54, v62
  v_mul_f32 v55, v55, v63
  v_cvt_pk_bf16_f32 v48, v48, v49
  v_cvt_pk_bf16_f32 v49, v50, v51
  v_cvt_pk_bf16_f32 v50, v52, v53
  v_cvt_pk_bf16_f32 v51, v54, v55
  s_add_u32 s42, s49, 0
  buffer_store_dwordx4 v[48:51], v131, s[32:35], s42 offen offset:2048 sc1
  ds_read_b64_tr_b16 v[12:13], v3 offset:34080
  ds_read_b64_tr_b16 v[14:15], v3 offset:34848
  s_waitcnt lgkmcnt(10)
  v_mfma_f32_32x32x16_bf16 v[96:111], v[16:19], v[252:255], v[96:111]
  ds_read_b128 v[144:147], v130 offset:288
  ds_read_b128 v[148:151], v130 offset:352
  s_waitcnt lgkmcnt(10)
  v_fmac_f32 v64, v128, v136
  v_fmac_f32 v65, v128, v137
  v_fmac_f32 v66, v128, v138
  v_fmac_f32 v67, v128, v139
  v_fmac_f32 v72, v128, v140
  s_waitcnt lgkmcnt(8)
  v_mfma_f32_32x32x16_bf16 v[112:127], v[20:23], v[240:243], v[112:127]
  v_fmac_f32 v73, v128, v141
  v_fmac_f32 v74, v128, v142
  v_fmac_f32 v75, v128, v143
  v_max_f32 v64, 0, v64
  v_max_f32 v65, 0, v65
  v_max_f32 v66, 0, v66
  v_max_f32 v67, 0, v67
  s_waitcnt lgkmcnt(6)
  v_mfma_f32_32x32x16_bf16 v[112:127], v[24:27], v[244:247], v[112:127]
  v_mul_f32 v72, v129, v72
  v_mul_f32 v73, v129, v73
  v_mul_f32 v74, v129, v74
  v_mul_f32 v75, v129, v75
  v_mul_f32 v64, v64, v72
  v_mul_f32 v65, v65, v73
  v_mul_f32 v66, v66, v74
  s_waitcnt lgkmcnt(4)
  v_mfma_f32_32x32x16_bf16 v[112:127], v[8:11], v[248:251], v[112:127]
  v_mul_f32 v67, v67, v75
  ds_read_b128 v[136:139], v130 offset:384
  ds_read_b128 v[140:143], v130 offset:448
  s_waitcnt lgkmcnt(2)
  v_fmac_f32 v68, v128, v144
  v_fmac_f32 v69, v128, v145
  v_fmac_f32 v70, v128, v146
  v_fmac_f32 v71, v128, v147
  v_mfma_f32_32x32x16_bf16 v[112:127], v[12:15], v[252:255], v[112:127]
  v_mov_b32 v6, 15
  ds_write_b32 v5, v6 offset:0
  v_fmac_f32 v76, v128, v148
  v_fmac_f32 v77, v128, v149
  v_fmac_f32 v78, v128, v150
  v_fmac_f32 v79, v128, v151
  v_max_f32 v68, 0, v68
  v_max_f32 v69, 0, v69
  v_max_f32 v70, 0, v70
  v_mov_b32 v254, 0
  v_mov_b32 v132, 163696
  ds_read_b64 v[252:253], v132 offset:0
  v_max_f32 v71, 0, v71
  v_mul_f32 v76, v129, v76
  v_mul_f32 v77, v129, v77
  v_mul_f32 v78, v129, v78
  v_mul_f32 v79, v129, v79
  v_mul_f32 v68, v68, v76
  v_mul_f32 v69, v69, v77
  v_mul_f32 v70, v70, v78
  v_mul_f32 v71, v71, v79
  v_cvt_pk_bf16_f32 v64, v64, v65
  v_cvt_pk_bf16_f32 v65, v66, v67
  v_cvt_pk_bf16_f32 v66, v68, v69
  v_cvt_pk_bf16_f32 v67, v70, v71
  s_add_u32 s42, s49, 4096
  buffer_store_dwordx4 v[64:67], v131, s[32:35], s42 offen sc1
  ds_read_b128 v[144:147], v130 offset:416
  ds_read_b128 v[148:151], v130 offset:480
  s_waitcnt lgkmcnt(4)
  v_fmac_f32 v80, v128, v136
  v_fmac_f32 v81, v128, v137
  v_fmac_f32 v82, v128, v138
  v_fmac_f32 v83, v128, v139
  v_fmac_f32 v88, v128, v140
  v_fmac_f32 v89, v128, v141
  v_fmac_f32 v90, v128, v142
  v_fmac_f32 v91, v128, v143
  v_max_f32 v80, 0, v80
  v_max_f32 v81, 0, v81
  v_max_f32 v82, 0, v82
  v_max_f32 v83, 0, v83
  v_mul_f32 v88, v129, v88
  v_mul_f32 v89, v129, v89
  v_mul_f32 v90, v129, v90
  v_mul_f32 v91, v129, v91
  v_mul_f32 v80, v80, v88
  v_mul_f32 v81, v81, v89
  v_mul_f32 v82, v82, v90
  v_mul_f32 v83, v83, v91
  ds_read_b128 v[136:139], v130 offset:512
  ds_read_b128 v[140:143], v130 offset:576
  s_waitcnt lgkmcnt(2)
  v_fmac_f32 v84, v128, v144
  v_fmac_f32 v85, v128, v145
  v_fmac_f32 v86, v128, v146
  v_fmac_f32 v87, v128, v147
  v_fmac_f32 v92, v128, v148
  v_fmac_f32 v93, v128, v149
  v_fmac_f32 v94, v128, v150
  v_fmac_f32 v95, v128, v151
  v_max_f32 v84, 0, v84
  v_max_f32 v85, 0, v85
  v_max_f32 v86, 0, v86
  v_max_f32 v87, 0, v87
  v_mul_f32 v92, v129, v92
  v_mul_f32 v93, v129, v93
  v_mul_f32 v94, v129, v94
  v_mul_f32 v95, v129, v95
  v_mul_f32 v84, v84, v92
  v_mul_f32 v85, v85, v93
  v_mul_f32 v86, v86, v94
  v_mul_f32 v87, v87, v95
  v_cvt_pk_bf16_f32 v80, v80, v81
  v_cvt_pk_bf16_f32 v81, v82, v83
  v_cvt_pk_bf16_f32 v82, v84, v85
  v_cvt_pk_bf16_f32 v83, v86, v87
  s_add_u32 s42, s49, 4096
  buffer_store_dwordx4 v[80:83], v131, s[32:35], s42 offen offset:2048 sc1
  ds_read_b128 v[144:147], v130 offset:544
  ds_read_b128 v[148:151], v130 offset:608
  s_waitcnt lgkmcnt(2)
  v_fmac_f32 v96, v128, v136
  v_fmac_f32 v97, v128, v137
  v_fmac_f32 v98, v128, v138
  v_fmac_f32 v99, v128, v139
  v_fmac_f32 v104, v128, v140
  v_fmac_f32 v105, v128, v141
  v_fmac_f32 v106, v128, v142
  v_fmac_f32 v107, v128, v143
  v_max_f32 v96, 0, v96
  v_max_f32 v97, 0, v97
  v_max_f32 v98, 0, v98
  v_max_f32 v99, 0, v99
  v_mul_f32 v104, v129, v104
  v_mul_f32 v105, v129, v105
  v_mul_f32 v106, v129, v106
  v_mul_f32 v107, v129, v107
  v_mul_f32 v96, v96, v104
  v_mul_f32 v97, v97, v105
  v_mul_f32 v98, v98, v106
  v_mul_f32 v99, v99, v107
  ds_read_b128 v[136:139], v130 offset:640
  ds_read_b128 v[140:143], v130 offset:704
  s_waitcnt lgkmcnt(2)
  v_fmac_f32 v100, v128, v144
  v_fmac_f32 v101, v128, v145
  v_fmac_f32 v102, v128, v146
  v_fmac_f32 v103, v128, v147
  v_fmac_f32 v108, v128, v148
  v_fmac_f32 v109, v128, v149
  v_fmac_f32 v110, v128, v150
  v_fmac_f32 v111, v128, v151
  v_max_f32 v100, 0, v100
  v_max_f32 v101, 0, v101
  v_max_f32 v102, 0, v102
  v_max_f32 v103, 0, v103
  v_mul_f32 v108, v129, v108
  v_mul_f32 v109, v129, v109
  v_mul_f32 v110, v129, v110
  v_mul_f32 v111, v129, v111
  v_mul_f32 v100, v100, v108
  v_mul_f32 v101, v101, v109
  v_mul_f32 v102, v102, v110
  v_mul_f32 v103, v103, v111
  v_cvt_pk_bf16_f32 v96, v96, v97
  v_cvt_pk_bf16_f32 v97, v98, v99
  v_cvt_pk_bf16_f32 v98, v100, v101
  v_cvt_pk_bf16_f32 v99, v102, v103
  s_add_u32 s42, s49, 8192
  buffer_store_dwordx4 v[96:99], v131, s[32:35], s42 offen sc1
  ds_read_b128 v[144:147], v130 offset:672
  ds_read_b128 v[148:151], v130 offset:736
  s_waitcnt lgkmcnt(2)
  v_fmac_f32 v112, v128, v136
  v_fmac_f32 v113, v128, v137
  v_fmac_f32 v114, v128, v138
  v_fmac_f32 v115, v128, v139
  v_fmac_f32 v120, v128, v140
  v_fmac_f32 v121, v128, v141
  v_fmac_f32 v122, v128, v142
  v_fmac_f32 v123, v128, v143
  v_max_f32 v112, 0, v112
  v_max_f32 v113, 0, v113
  v_max_f32 v114, 0, v114
  v_max_f32 v115, 0, v115
  v_mul_f32 v120, v129, v120
  v_mul_f32 v121, v129, v121
  v_mul_f32 v122, v129, v122
  v_mul_f32 v123, v129, v123
  v_mul_f32 v112, v112, v120
  v_mul_f32 v113, v113, v121
  v_mul_f32 v114, v114, v122
  v_mul_f32 v115, v115, v123
  s_waitcnt lgkmcnt(0)
  v_fmac_f32 v116, v128, v144
  v_fmac_f32 v117, v128, v145
  v_fmac_f32 v118, v128, v146
  v_fmac_f32 v119, v128, v147
  v_fmac_f32 v124, v128, v148
  v_fmac_f32 v125, v128, v149
  v_fmac_f32 v126, v128, v150
  v_fmac_f32 v127, v128, v151
  v_max_f32 v116, 0, v116
  v_max_f32 v117, 0, v117
  v_max_f32 v118, 0, v118
  v_max_f32 v119, 0, v119
  v_mul_f32 v124, v129, v124
  v_mul_f32 v125, v129, v125
  v_mul_f32 v126, v129, v126
  v_mul_f32 v127, v129, v127
  v_mul_f32 v116, v116, v124
  v_mul_f32 v117, v117, v125
  v_mul_f32 v118, v118, v126
  v_mul_f32 v119, v119, v127
  v_cvt_pk_bf16_f32 v112, v112, v113
  v_cvt_pk_bf16_f32 v113, v114, v115
  v_cvt_pk_bf16_f32 v114, v116, v117
  v_cvt_pk_bf16_f32 v115, v118, v119
  s_add_u32 s42, s49, 8192
  buffer_store_dwordx4 v[112:115], v131, s[32:35], s42 offen offset:2048 sc1
  s_setprio 0
  s_lshl_b32 s89, s39, 4
  s_add_u32 s89, s89, s40
  s_lshl_b32 s89, s89, 7
  s_add_u32 s89, s89, 14712832
  s_bfe_u32 s42, s2, 131073
  s_lshl_b32 s42, s42, 3
  s_bfe_u32 s43, s2, 196611
  s_add_u32 s84, s42, s43
  s_and_b32 s43, s2, 1
  s_lshl_b32 s43, s43, 2
  s_lshr_b32 s85, s2, 6
  s_add_u32 s85, s85, s43
  s_mul_i32 s42, s84, 176128
  s_add_u32 s42, s42, 6291456
  s_add_u32 s72, s22, s42
  s_addc_u32 s73, s23, 0
  s_mov_b32 s74, 176128
  s_mov_b32 s75, 131072
  s_mov_b32 s80, s8
  s_mov_b32 s81, s9
  s_mov_b32 s82, 524288
  s_mov_b32 s83, 131072
  s_mul_i32 s42, s37, 45056
  v_add_u32 v132, s42, v131
  v_bfe_u32 v142, v0, 4, 1
  v_lshlrev_b32 v142, 2, v142
  v_xor_b32 v142, v142, v0
  v_and_b32 v142, 7, v142
  v_lshlrev_b32 v142, 4, v142
  v_lshrrev_b32 v141, 3, v0
  v_lshl_add_u32 v141, v141, 10, v142
  s_lshl_b32 s42, s85, 7
  s_mul_i32 s43, s37, 360448
  s_add_u32 s43, s43, s42
  s_lshl_b32 s43, s37, 17
  s_add_u32 s43, s43, s42
  v_add_u32 v137, s43, v141
  v_add_u32 v138, 7168, v137
  v_lshrrev_b32 v141, 5, v0
  v_lshlrev_b32 v141, 2, v141
  v_bfe_u32 v142, v0, 2, 2
  v_add_u32 v141, v141, v142
  v_and_b32 v143, 3, v0
  v_lshlrev_b32 v143, 3, v143
  v_lshl_add_u32 v141, v141, 7, v143
  v_lshrrev_b32 v142, 1, v142
  v_bfe_u32 v143, v0, 4, 1
  v_lshl_add_u32 v142, v142, 1, v143
  v_lshl_add_u32 v141, v142, 5, v141
  v_add_u32 v135, s86, v141
  v_xor_b32 v136, 64, v135
  v_add_u32 v140, s86, v131
  s_lshr_b32 s42, s84, 1
  s_lshl_b32 s42, s42, 11
  s_add_u32 s42, s42, 14712832
  s_mul_i32 s43, s37, 11
  s_mul_i32 s43, s43, 21846
  s_lshr_b32 s43, s43, 16
  v_min_u32 v141, 4, v0
  v_add_u32 v141, s43, v141
  v_min_u32 v141, 14, v141
  v_lshlrev_b32 v141, 7, v141
  v_add_u32 v139, s42, v141
  ds_read_b128 v[8:11], v4 offset:16
  s_waitcnt vmcnt(0)
  v_mov_b32 v141, 163764
  v_mov_b32 v142, 1
  s_mov_b64 exec, 1
  ds_add_rtn_u32 v143, v141, v142
  s_waitcnt lgkmcnt(0)
  v_readfirstlane_b32 s48, v143
  s_nop 0
  s_cmp_lg_u32 s48, 3
  s_cbranch_scc1 nf_9b20_1015
  buffer_store_dwordx2 v[252:253], v254, s[32:35], s89 offen sc1
nf_9b20_1015:
  s_mov_b64 exec, -1
lsp_9b20_1016:
  v_min3_u32 v8, v8, v9, v10
  v_min_u32 v8, v8, v11
  v_cmp_gt_u32 vcc, 15, v8
  s_nop 4
  s_cbranch_vccz lok_9b20_1017
  s_add_u32 s3, s3, 1
  s_cmp_gt_u32 s3, 4194304
  s_cbranch_scc1 lok_9b20_1017
  ds_read_b128 v[8:11], v4 offset:16
  s_waitcnt lgkmcnt(0)
  s_branch lsp_9b20_1016
lok_9b20_1017:
  s_add_u32 m0, s86, 0
  s_mov_b32 s88, 0
  buffer_load_dwordx4 v7, s[76:79], s88 offen lds
  s_mov_b32 s88, 7168
  buffer_load_dwordx4 v7, s[76:79], s88 offen offset:1024 lds
  s_add_u32 m0, s86, 2048
  s_mov_b32 s88, 16384
  buffer_load_dwordx4 v7, s[76:79], s88 offen lds
  s_mov_b32 s88, 23552
  buffer_load_dwordx4 v7, s[76:79], s88 offen offset:1024 lds
  s_add_u32 m0, s86, 4096
  s_mov_b32 s88, 32768
  buffer_load_dwordx4 v7, s[76:79], s88 offen lds
  s_mov_b32 s88, 39936
  buffer_load_dwordx4 v7, s[76:79], s88 offen offset:1024 lds
  s_add_u32 m0, s86, 6144
  s_mov_b32 s88, 49152
  buffer_load_dwordx4 v7, s[76:79], s88 offen lds
  s_mov_b32 s88, 56320
  buffer_load_dwordx4 v7, s[76:79], s88 offen offset:1024 lds
  s_add_u32 m0, s86, 8192
  s_mov_b32 s88, 65536
  buffer_load_dwordx4 v7, s[76:79], s88 offen lds
  s_mov_b32 s88, 72704
  buffer_load_dwordx4 v7, s[76:79], s88 offen offset:1024 lds
  s_add_u32 m0, s86, 10240
  s_mov_b32 s88, 81920
  buffer_load_dwordx4 v7, s[76:79], s88 offen lds
  s_mov_b32 s88, 89088
  buffer_load_dwordx4 v7, s[76:79], s88 offen offset:1024 lds
  s_add_u32 m0, s86, 12288
  s_mov_b32 s88, 98304
  buffer_load_dwordx4 v7, s[76:79], s88 offen lds
  s_mov_b32 s88, 105472
  buffer_load_dwordx4 v7, s[76:79], s88 offen offset:1024 lds
  s_add_u32 m0, s86, 14336
  s_mov_b32 s88, 114688
  buffer_load_dwordx4 v7, s[76:79], s88 offen lds
  s_mov_b32 s88, 121856
  buffer_load_dwordx4 v7, s[76:79], s88 offen offset:1024 lds
  s_add_u32 m0, s86, 16384
  s_mov_b32 s88, 131072
  buffer_load_dwordx4 v7, s[76:79], s88 offen lds
  s_mov_b32 s88, 138240
  buffer_load_dwordx4 v7, s[76:79], s88 offen offset:1024 lds
  s_lshl_b32 s49, s37, 14
  s_add_u32 m0, s49, 73728
  s_mov_b32 s88, 0
  buffer_load_dwordx4 v137, s[80:83], s88 offen lds
  buffer_load_dwordx4 v138, s[80:83], s88 offen offset:1024 lds
  s_add_u32 m0, s49, 75776
  s_mov_b32 s88, 16384
  buffer_load_dwordx4 v137, s[80:83], s88 offen lds
  buffer_load_dwordx4 v138, s[80:83], s88 offen offset:1024 lds
  s_add_u32 m0, s49, 77824
  s_mov_b32 s88, 32768
  buffer_load_dwordx4 v137, s[80:83], s88 offen lds
  buffer_load_dwordx4 v138, s[80:83], s88 offen offset:1024 lds
  s_add_u32 m0, s49, 79872
  s_mov_b32 s88, 49152
  buffer_load_dwordx4 v137, s[80:83], s88 offen lds
  buffer_load_dwordx4 v138, s[80:83], s88 offen offset:1024 lds
  s_add_u32 m0, s49, 81920
  s_mov_b32 s88, 65536
  buffer_load_dwordx4 v137, s[80:83], s88 offen lds
  buffer_load_dwordx4 v138, s[80:83], s88 offen offset:1024 lds
  s_add_u32 m0, s49, 83968
  s_mov_b32 s88, 81920
  buffer_load_dwordx4 v137, s[80:83], s88 offen lds
  buffer_load_dwordx4 v138, s[80:83], s88 offen offset:1024 lds
  s_add_u32 m0, s49, 86016
  s_mov_b32 s88, 98304
  buffer_load_dwordx4 v137, s[80:83], s88 offen lds
  buffer_load_dwordx4 v138, s[80:83], s88 offen offset:1024 lds
  s_add_u32 m0, s49, 88064
  s_mov_b32 s88, 114688
  buffer_load_dwordx4 v137, s[80:83], s88 offen lds
  buffer_load_dwordx4 v138, s[80:83], s88 offen offset:1024 lds
  buffer_load_dwordx2 v[144:145], v139, s[32:35], 0 offen sc1
  s_waitcnt vmcnt(0)
poll_9b20_1018:
  v_cmp_ne_u64 vcc, v[144:145], v[252:253]
  s_nop 4
  s_cbranch_vccz pok_9b20_1019
  s_add_u32 s3, s3, 1
  s_cmp_gt_u32 s3, 4194304
  s_cbranch_scc1 pok_9b20_1019
  s_sleep 8
  buffer_load_dwordx2 v[144:145], v139, s[32:35], 0 offen sc1
  s_waitcnt vmcnt(0)
  s_branch poll_9b20_1018
pok_9b20_1019:
  s_mov_b32 s87, 0
  buffer_load_dwordx4 v[160:163], v132, s[72:75], s87 offen sc1
  buffer_load_dwordx4 v[164:167], v132, s[72:75], s87 offen offset:1024 sc1
  s_mov_b32 s87, 2048
  buffer_load_dwordx4 v[168:171], v132, s[72:75], s87 offen sc1
  buffer_load_dwordx4 v[172:175], v132, s[72:75], s87 offen offset:1024 sc1
  s_mov_b32 s87, 4096
  buffer_load_dwordx4 v[176:179], v132, s[72:75], s87 offen sc1
  buffer_load_dwordx4 v[180:183], v132, s[72:75], s87 offen offset:1024 sc1
  s_mov_b32 s87, 6144
  buffer_load_dwordx4 v[184:187], v132, s[72:75], s87 offen sc1
  buffer_load_dwordx4 v[188:191], v132, s[72:75], s87 offen offset:1024 sc1
  s_mov_b32 s87, 8192
  buffer_load_dwordx4 v[192:195], v132, s[72:75], s87 offen sc1
  buffer_load_dwordx4 v[196:199], v132, s[72:75], s87 offen offset:1024 sc1
  ds_read_b64_tr_b16 v[144:145], v135 offset:0
  ds_read_b64_tr_b16 v[146:147], v135 offset:1024
  ds_read_b64_tr_b16 v[148:149], v136 offset:0
  ds_read_b64_tr_b16 v[150:151], v136 offset:1024
  s_waitcnt vmcnt(8) lgkmcnt(0)
  v_mfma_f32_32x32x16_bf16 v[32:47], v[144:147], v[160:163], 0
  ds_read_b64_tr_b16 v[152:153], v135 offset:2048
  ds_read_b64_tr_b16 v[154:155], v135 offset:3072
  s_add_u32 m0, s86, 0
  s_mov_b32 s88, 147456
  buffer_load_dwordx4 v7, s[76:79], s88 offen lds
  v_mfma_f32_32x32x16_bf16 v[48:63], v[148:151], v[160:163], 0
  ds_read_b64_tr_b16 v[156:157], v136 offset:2048
  ds_read_b64_tr_b16 v[158:159], v136 offset:3072
  s_mov_b32 s88, 154624
  buffer_load_dwordx4 v7, s[76:79], s88 offen offset:1024 lds
  v_mfma_f32_32x32x16_bf16 v[64:79], v[144:147], v[164:167], 0
  v_mfma_f32_32x32x16_bf16 v[80:95], v[148:151], v[164:167], 0
  s_waitcnt vmcnt(8) lgkmcnt(0)
  v_mfma_f32_32x32x16_bf16 v[32:47], v[152:155], v[168:171], v[32:47]
  ds_read_b64_tr_b16 v[144:145], v135 offset:4096
  ds_read_b64_tr_b16 v[146:147], v135 offset:5120
  s_mov_b32 s87, 10240
  buffer_load_dwordx4 v[160:163], v132, s[72:75], s87 offen sc1
  v_mfma_f32_32x32x16_bf16 v[48:63], v[156:159], v[168:171], v[48:63]
  ds_read_b64_tr_b16 v[148:149], v136 offset:4096
  ds_read_b64_tr_b16 v[150:151], v136 offset:5120
  buffer_load_dwordx4 v[164:167], v132, s[72:75], s87 offen offset:1024 sc1
  v_mfma_f32_32x32x16_bf16 v[64:79], v[152:155], v[172:175], v[64:79]
  s_add_u32 m0, s86, 2048
  s_mov_b32 s88, 163840
  buffer_load_dwordx4 v7, s[76:79], s88 offen lds
  v_mfma_f32_32x32x16_bf16 v[80:95], v[156:159], v[172:175], v[80:95]
  s_mov_b32 s88, 171008
  buffer_load_dwordx4 v7, s[76:79], s88 offen offset:1024 lds
  s_waitcnt vmcnt(10) lgkmcnt(0)
  v_mfma_f32_32x32x16_bf16 v[32:47], v[144:147], v[176:179], v[32:47]
  ds_read_b64_tr_b16 v[152:153], v135 offset:6144
  ds_read_b64_tr_b16 v[154:155], v135 offset:7168
  s_mov_b32 s87, 12288
  buffer_load_dwordx4 v[168:171], v132, s[72:75], s87 offen sc1
  v_mfma_f32_32x32x16_bf16 v[48:63], v[148:151], v[176:179], v[48:63]
  ds_read_b64_tr_b16 v[156:157], v136 offset:6144
  ds_read_b64_tr_b16 v[158:159], v136 offset:7168
  buffer_load_dwordx4 v[172:175], v132, s[72:75], s87 offen offset:1024 sc1
  v_mfma_f32_32x32x16_bf16 v[64:79], v[144:147], v[180:183], v[64:79]
  s_add_u32 m0, s86, 4096
  s_mov_b32 s88, 180224
  buffer_load_dwordx4 v7, s[76:79], s88 offen lds
  v_mfma_f32_32x32x16_bf16 v[80:95], v[148:151], v[180:183], v[80:95]
  s_mov_b32 s88, 187392
  buffer_load_dwordx4 v7, s[76:79], s88 offen offset:1024 lds
  s_waitcnt vmcnt(12) lgkmcnt(0)
  v_mfma_f32_32x32x16_bf16 v[32:47], v[152:155], v[184:187], v[32:47]
  ds_read_b64_tr_b16 v[144:145], v135 offset:8192
  ds_read_b64_tr_b16 v[146:147], v135 offset:9216
  s_mov_b32 s87, 14336
  buffer_load_dwordx4 v[176:179], v132, s[72:75], s87 offen sc1
  v_mfma_f32_32x32x16_bf16 v[48:63], v[156:159], v[184:187], v[48:63]
  ds_read_b64_tr_b16 v[148:149], v136 offset:8192
  ds_read_b64_tr_b16 v[150:151], v136 offset:9216
  buffer_load_dwordx4 v[180:183], v132, s[72:75], s87 offen offset:1024 sc1
  v_mfma_f32_32x32x16_bf16 v[64:79], v[152:155], v[188:191], v[64:79]
  s_add_u32 m0, s86, 6144
  s_mov_b32 s88, 196608
  buffer_load_dwordx4 v7, s[76:79], s88 offen lds
  v_mfma_f32_32x32x16_bf16 v[80:95], v[156:159], v[188:191], v[80:95]
  s_mov_b32 s88, 203776
  buffer_load_dwordx4 v7, s[76:79], s88 offen offset:1024 lds
  s_waitcnt vmcnt(14) lgkmcnt(0)
  v_mfma_f32_32x32x16_bf16 v[32:47], v[144:147], v[192:195], v[32:47]
  ds_read_b64_tr_b16 v[152:153], v135 offset:10240
  ds_read_b64_tr_b16 v[154:155], v135 offset:11264
  s_mov_b32 s87, 16384
  buffer_load_dwordx4 v[184:187], v132, s[72:75], s87 offen sc1
  v_mfma_f32_32x32x16_bf16 v[48:63], v[148:151], v[192:195], v[48:63]
  ds_read_b64_tr_b16 v[156:157], v136 offset:10240
  ds_read_b64_tr_b16 v[158:159], v136 offset:11264
  buffer_load_dwordx4 v[188:191], v132, s[72:75], s87 offen offset:1024 sc1
  v_mfma_f32_32x32x16_bf16 v[64:79], v[144:147], v[196:199], v[64:79]
  s_add_u32 m0, s86, 8192
  s_mov_b32 s88, 212992
  buffer_load_dwordx4 v7, s[76:79], s88 offen lds
  v_mfma_f32_32x32x16_bf16 v[80:95], v[148:151], v[196:199], v[80:95]
  s_mov_b32 s88, 220160
  buffer_load_dwordx4 v7, s[76:79], s88 offen offset:1024 lds
  s_waitcnt vmcnt(14) lgkmcnt(0)
  v_mfma_f32_32x32x16_bf16 v[32:47], v[152:155], v[160:163], v[32:47]
  ds_read_b64_tr_b16 v[144:145], v135 offset:12288
  ds_read_b64_tr_b16 v[146:147], v135 offset:13312
  s_mov_b32 s87, 18432
  buffer_load_dwordx4 v[192:195], v132, s[72:75], s87 offen sc1
  v_mfma_f32_32x32x16_bf16 v[48:63], v[156:159], v[160:163], v[48:63]
  ds_read_b64_tr_b16 v[148:149], v136 offset:12288
  ds_read_b64_tr_b16 v[150:151], v136 offset:13312
  buffer_load_dwordx4 v[196:199], v132, s[72:75], s87 offen offset:1024 sc1
  v_mfma_f32_32x32x16_bf16 v[64:79], v[152:155], v[164:167], v[64:79]
  s_add_u32 m0, s86, 10240
  s_mov_b32 s88, 229376
  buffer_load_dwordx4 v7, s[76:79], s88 offen lds
  v_mfma_f32_32x32x16_bf16 v[80:95], v[156:159], v[164:167], v[80:95]
  s_mov_b32 s88, 236544
  buffer_load_dwordx4 v7, s[76:79], s88 offen offset:1024 lds
  s_waitcnt vmcnt(14) lgkmcnt(0)
  v_mfma_f32_32x32x16_bf16 v[32:47], v[144:147], v[168:171], v[32:47]
  ds_read_b64_tr_b16 v[152:153], v135 offset:14336
  ds_read_b64_tr_b16 v[154:155], v135 offset:15360
  s_mov_b32 s87, 20480
  buffer_load_dwordx4 v[160:163], v132, s[72:75], s87 offen sc1
  v_mfma_f32_32x32x16_bf16 v[48:63], v[148:151], v[168:171], v[48:63]
  ds_read_b64_tr_b16 v[156:157], v136 offset:14336
  ds_read_b64_tr_b16 v[158:159], v136 offset:15360
  buffer_load_dwordx4 v[164:167], v132, s[72:75], s87 offen offset:1024 sc1
  v_mfma_f32_32x32x16_bf16 v[64:79], v[144:147], v[172:175], v[64:79]
  s_add_u32 m0, s86, 12288
  s_mov_b32 s88, 245760
  buffer_load_dwordx4 v7, s[76:79], s88 offen lds
  v_mfma_f32_32x32x16_bf16 v[80:95], v[148:151], v[172:175], v[80:95]
  s_mov_b32 s88, 252928
  buffer_load_dwordx4 v7, s[76:79], s88 offen offset:1024 lds
  s_waitcnt vmcnt(14) lgkmcnt(0)
  v_mfma_f32_32x32x16_bf16 v[32:47], v[152:155], v[176:179], v[32:47]
  ds_read_b64_tr_b16 v[144:145], v135 offset:16384
  ds_read_b64_tr_b16 v[146:147], v135 offset:17408
  s_mov_b32 s87, 22528
  buffer_load_dwordx4 v[168:171], v132, s[72:75], s87 offen sc1
  v_mfma_f32_32x32x16_bf16 v[48:63], v[156:159], v[176:179], v[48:63]
  ds_read_b64_tr_b16 v[148:149], v136 offset:16384
  ds_read_b64_tr_b16 v[150:151], v136 offset:17408
  buffer_load_dwordx4 v[172:175], v132, s[72:75], s87 offen offset:1024 sc1
  v_mfma_f32_32x32x16_bf16 v[64:79], v[152:155], v[180:183], v[64:79]
  s_add_u32 m0, s86, 14336
  s_mov_b32 s88, 262144
  buffer_load_dwordx4 v7, s[76:79], s88 offen lds
  v_mfma_f32_32x32x16_bf16 v[80:95], v[156:159], v[180:183], v[80:95]
  s_mov_b32 s88, 269312
  buffer_load_dwordx4 v7, s[76:79], s88 offen offset:1024 lds
  s_waitcnt vmcnt(14) lgkmcnt(0)
  v_mfma_f32_32x32x16_bf16 v[32:47], v[144:147], v[184:187], v[32:47]
  ds_read_b64_tr_b16 v[152:153], v135 offset:0
  ds_read_b64_tr_b16 v[154:155], v135 offset:1024
  s_mov_b32 s87, 24576
  buffer_load_dwordx4 v[176:179], v132, s[72:75], s87 offen sc1
  v_mfma_f32_32x32x16_bf16 v[48:63], v[148:151], v[184:187], v[48:63]
  ds_read_b64_tr_b16 v[156:157], v136 offset:0
  ds_read_b64_tr_b16 v[158:159], v136 offset:1024
  buffer_load_dwordx4 v[180:183], v132, s[72:75], s87 offen offset:1024 sc1
  v_mfma_f32_32x32x16_bf16 v[64:79], v[144:147], v[188:191], v[64:79]
  s_add_u32 m0, s86, 16384
  s_mov_b32 s88, 278528
  buffer_load_dwordx4 v7, s[76:79], s88 offen lds
  v_mfma_f32_32x32x16_bf16 v[80:95], v[148:151], v[188:191], v[80:95]
  s_mov_b32 s88, 285696
  buffer_load_dwordx4 v7, s[76:79], s88 offen offset:1024 lds
  s_waitcnt vmcnt(14) lgkmcnt(0)
  v_mfma_f32_32x32x16_bf16 v[32:47], v[152:155], v[192:195], v[32:47]
  ds_read_b64_tr_b16 v[144:145], v135 offset:2048
  ds_read_b64_tr_b16 v[146:147], v135 offset:3072
  s_mov_b32 s87, 26624
  buffer_load_dwordx4 v[184:187], v132, s[72:75], s87 offen sc1
  v_mfma_f32_32x32x16_bf16 v[48:63], v[156:159], v[192:195], v[48:63]
  ds_read_b64_tr_b16 v[148:149], v136 offset:2048
  ds_read_b64_tr_b16 v[150:151], v136 offset:3072
  buffer_load_dwordx4 v[188:191], v132, s[72:75], s87 offen offset:1024 sc1
  v_mfma_f32_32x32x16_bf16 v[64:79], v[152:155], v[196:199], v[64:79]
  s_add_u32 m0, s86, 0
  s_mov_b32 s88, 294912
  buffer_load_dwordx4 v7, s[76:79], s88 offen lds
  v_mfma_f32_32x32x16_bf16 v[80:95], v[156:159], v[196:199], v[80:95]
  s_mov_b32 s88, 302080
  buffer_load_dwordx4 v7, s[76:79], s88 offen offset:1024 lds
  s_waitcnt vmcnt(14) lgkmcnt(0)
  v_mfma_f32_32x32x16_bf16 v[32:47], v[144:147], v[160:163], v[32:47]
  ds_read_b64_tr_b16 v[152:153], v135 offset:4096
  ds_read_b64_tr_b16 v[154:155], v135 offset:5120
  s_mov_b32 s87, 28672
  buffer_load_dwordx4 v[192:195], v132, s[72:75], s87 offen sc1
  v_mfma_f32_32x32x16_bf16 v[48:63], v[148:151], v[160:163], v[48:63]
  ds_read_b64_tr_b16 v[156:157], v136 offset:4096
  ds_read_b64_tr_b16 v[158:159], v136 offset:5120
  buffer_load_dwordx4 v[196:199], v132, s[72:75], s87 offen offset:1024 sc1
  v_mfma_f32_32x32x16_bf16 v[64:79], v[144:147], v[164:167], v[64:79]
  s_add_u32 m0, s86, 2048
  s_mov_b32 s88, 311296
  buffer_load_dwordx4 v7, s[76:79], s88 offen lds
  v_mfma_f32_32x32x16_bf16 v[80:95], v[148:151], v[164:167], v[80:95]
  s_mov_b32 s88, 318464
  buffer_load_dwordx4 v7, s[76:79], s88 offen offset:1024 lds
  s_waitcnt vmcnt(14) lgkmcnt(0)
  v_mfma_f32_32x32x16_bf16 v[32:47], v[152:155], v[168:171], v[32:47]
  ds_read_b64_tr_b16 v[144:145], v135 offset:6144
  ds_read_b64_tr_b16 v[146:147], v135 offset:7168
  s_mov_b32 s87, 30720
  buffer_load_dwordx4 v[160:163], v132, s[72:75], s87 offen sc1
  v_mfma_f32_32x32x16_bf16 v[48:63], v[156:159], v[168:171], v[48:63]
  ds_read_b64_tr_b16 v[148:149], v136 offset:6144
  ds_read_b64_tr_b16 v[150:151], v136 offset:7168
  buffer_load_dwordx4 v[164:167], v132, s[72:75], s87 offen offset:1024 sc1
  v_mfma_f32_32x32x16_bf16 v[64:79], v[152:155], v[172:175], v[64:79]
  s_add_u32 m0, s86, 4096
  s_mov_b32 s88, 327680
  buffer_load_dwordx4 v7, s[76:79], s88 offen lds
  v_mfma_f32_32x32x16_bf16 v[80:95], v[156:159], v[172:175], v[80:95]
  s_mov_b32 s88, 334848
  buffer_load_dwordx4 v7, s[76:79], s88 offen offset:1024 lds
  s_waitcnt vmcnt(14) lgkmcnt(0)
  v_mfma_f32_32x32x16_bf16 v[32:47], v[144:147], v[176:179], v[32:47]
  ds_read_b64_tr_b16 v[152:153], v135 offset:8192
  ds_read_b64_tr_b16 v[154:155], v135 offset:9216
  s_mov_b32 s87, 32768
  buffer_load_dwordx4 v[168:171], v132, s[72:75], s87 offen sc1
  v_mfma_f32_32x32x16_bf16 v[48:63], v[148:151], v[176:179], v[48:63]
  ds_read_b64_tr_b16 v[156:157], v136 offset:8192
  ds_read_b64_tr_b16 v[158:159], v136 offset:9216
  buffer_load_dwordx4 v[172:175], v132, s[72:75], s87 offen offset:1024 sc1
  v_mfma_f32_32x32x16_bf16 v[64:79], v[144:147], v[180:183], v[64:79]
  s_add_u32 m0, s86, 6144
  s_mov_b32 s88, 344064
  buffer_load_dwordx4 v7, s[76:79], s88 offen lds
  v_mfma_f32_32x32x16_bf16 v[80:95], v[148:151], v[180:183], v[80:95]
  s_mov_b32 s88, 351232
  buffer_load_dwordx4 v7, s[76:79], s88 offen offset:1024 lds
  s_waitcnt vmcnt(14) lgkmcnt(0)
  v_mfma_f32_32x32x16_bf16 v[32:47], v[152:155], v[184:187], v[32:47]
  ds_read_b64_tr_b16 v[144:145], v135 offset:10240
  ds_read_b64_tr_b16 v[146:147], v135 offset:11264
  s_mov_b32 s87, 34816
  buffer_load_dwordx4 v[176:179], v132, s[72:75], s87 offen sc1
  v_mfma_f32_32x32x16_bf16 v[48:63], v[156:159], v[184:187], v[48:63]
  ds_read_b64_tr_b16 v[148:149], v136 offset:10240
  ds_read_b64_tr_b16 v[150:151], v136 offset:11264
  buffer_load_dwordx4 v[180:183], v132, s[72:75], s87 offen offset:1024 sc1
  v_mfma_f32_32x32x16_bf16 v[64:79], v[152:155], v[188:191], v[64:79]
  v_mfma_f32_32x32x16_bf16 v[80:95], v[156:159], v[188:191], v[80:95]
  s_lshl_b32 s48, s37, 2
  s_add_u32 s48, s48, 163744
  v_mov_b32 v141, s48
  v_mov_b32 v142, 1
  ds_write_b32 v141, v142 offset:0
  s_waitcnt vmcnt(12) lgkmcnt(1)
  v_mfma_f32_32x32x16_bf16 v[32:47], v[144:147], v[192:195], v[32:47]
  ds_read_b64_tr_b16 v[152:153], v135 offset:12288
  ds_read_b64_tr_b16 v[154:155], v135 offset:13312
  s_mov_b32 s87, 36864
  buffer_load_dwordx4 v[184:187], v132, s[72:75], s87 offen sc1
  v_mfma_f32_32x32x16_bf16 v[48:63], v[148:151], v[192:195], v[48:63]
  ds_read_b64_tr_b16 v[156:157], v136 offset:12288
  ds_read_b64_tr_b16 v[158:159], v136 offset:13312
  buffer_load_dwordx4 v[188:191], v132, s[72:75], s87 offen offset:1024 sc1
  v_mfma_f32_32x32x16_bf16 v[64:79], v[144:147], v[196:199], v[64:79]
  v_mfma_f32_32x32x16_bf16 v[80:95], v[148:151], v[196:199], v[80:95]
  s_waitcnt vmcnt(10) lgkmcnt(0)
  v_mfma_f32_32x32x16_bf16 v[32:47], v[152:155], v[160:163], v[32:47]
  ds_read_b64_tr_b16 v[144:145], v135 offset:14336
  ds_read_b64_tr_b16 v[146:147], v135 offset:15360
  s_mov_b32 s87, 38912
  buffer_load_dwordx4 v[192:195], v132, s[72:75], s87 offen sc1
  v_mfma_f32_32x32x16_bf16 v[48:63], v[156:159], v[160:163], v[48:63]
  ds_read_b64_tr_b16 v[148:149], v136 offset:14336
  ds_read_b64_tr_b16 v[150:151], v136 offset:15360
  buffer_load_dwordx4 v[196:199], v132, s[72:75], s87 offen offset:1024 sc1
  v_mfma_f32_32x32x16_bf16 v[64:79], v[152:155], v[164:167], v[64:79]
  v_mfma_f32_32x32x16_bf16 v[80:95], v[156:159], v[164:167], v[80:95]
  s_waitcnt vmcnt(8) lgkmcnt(0)
  v_mfma_f32_32x32x16_bf16 v[32:47], v[144:147], v[168:171], v[32:47]
  ds_read_b64_tr_b16 v[152:153], v135 offset:16384
  ds_read_b64_tr_b16 v[154:155], v135 offset:17408
  s_mov_b32 s87, 40960
  buffer_load_dwordx4 v[160:163], v132, s[72:75], s87 offen sc1
  v_mfma_f32_32x32x16_bf16 v[48:63], v[148:151], v[168:171], v[48:63]
  ds_read_b64_tr_b16 v[156:157], v136 offset:16384
  ds_read_b64_tr_b16 v[158:159], v136 offset:17408
  buffer_load_dwordx4 v[164:167], v132, s[72:75], s87 offen offset:1024 sc1
  v_mfma_f32_32x32x16_bf16 v[64:79], v[144:147], v[172:175], v[64:79]
  v_mfma_f32_32x32x16_bf16 v[80:95], v[148:151], v[172:175], v[80:95]
  s_waitcnt vmcnt(6) lgkmcnt(0)
  v_mfma_f32_32x32x16_bf16 v[32:47], v[152:155], v[176:179], v[32:47]
  ds_read_b64_tr_b16 v[144:145], v135 offset:0
  ds_read_b64_tr_b16 v[146:147], v135 offset:1024
  s_mov_b32 s87, 43008
  buffer_load_dwordx4 v[168:171], v132, s[72:75], s87 offen sc1
  v_mfma_f32_32x32x16_bf16 v[48:63], v[156:159], v[176:179], v[48:63]
  ds_read_b64_tr_b16 v[148:149], v136 offset:0
  ds_read_b64_tr_b16 v[150:151], v136 offset:1024
  buffer_load_dwordx4 v[172:175], v132, s[72:75], s87 offen offset:1024 sc1
  v_mfma_f32_32x32x16_bf16 v[64:79], v[152:155], v[180:183], v[64:79]
  v_mfma_f32_32x32x16_bf16 v[80:95], v[156:159], v[180:183], v[80:95]
  s_waitcnt vmcnt(6) lgkmcnt(0)
  v_mfma_f32_32x32x16_bf16 v[32:47], v[144:147], v[184:187], v[32:47]
  ds_read_b64_tr_b16 v[152:153], v135 offset:2048
  ds_read_b64_tr_b16 v[154:155], v135 offset:3072
  v_mfma_f32_32x32x16_bf16 v[48:63], v[148:151], v[184:187], v[48:63]
  ds_read_b64_tr_b16 v[156:157], v136 offset:2048
  ds_read_b64_tr_b16 v[158:159], v136 offset:3072
  v_mfma_f32_32x32x16_bf16 v[64:79], v[144:147], v[188:191], v[64:79]
  v_mfma_f32_32x32x16_bf16 v[80:95], v[148:151], v[188:191], v[80:95]
  s_waitcnt vmcnt(4) lgkmcnt(0)
  v_mfma_f32_32x32x16_bf16 v[32:47], v[152:155], v[192:195], v[32:47]
  ds_read_b64_tr_b16 v[144:145], v135 offset:4096
  ds_read_b64_tr_b16 v[146:147], v135 offset:5120
  v_mfma_f32_32x32x16_bf16 v[48:63], v[156:159], v[192:195], v[48:63]
  ds_read_b64_tr_b16 v[148:149], v136 offset:4096
  ds_read_b64_tr_b16 v[150:151], v136 offset:5120
  v_mfma_f32_32x32x16_bf16 v[64:79], v[152:155], v[196:199], v[64:79]
  v_mfma_f32_32x32x16_bf16 v[80:95], v[156:159], v[196:199], v[80:95]
  s_waitcnt vmcnt(2) lgkmcnt(0)
  v_mfma_f32_32x32x16_bf16 v[32:47], v[144:147], v[160:163], v[32:47]
  ds_read_b64_tr_b16 v[152:153], v135 offset:6144
  ds_read_b64_tr_b16 v[154:155], v135 offset:7168
  v_mfma_f32_32x32x16_bf16 v[48:63], v[148:151], v[160:163], v[48:63]
  ds_read_b64_tr_b16 v[156:157], v136 offset:6144
  ds_read_b64_tr_b16 v[158:159], v136 offset:7168
  v_mfma_f32_32x32x16_bf16 v[64:79], v[144:147], v[164:167], v[64:79]
  v_mfma_f32_32x32x16_bf16 v[80:95], v[148:151], v[164:167], v[80:95]
  s_waitcnt vmcnt(0) lgkmcnt(0)
  v_mfma_f32_32x32x16_bf16 v[32:47], v[152:155], v[168:171], v[32:47]
  v_mfma_f32_32x32x16_bf16 v[48:63], v[156:159], v[168:171], v[48:63]
  v_mfma_f32_32x32x16_bf16 v[64:79], v[152:155], v[172:175], v[64:79]
  v_mfma_f32_32x32x16_bf16 v[80:95], v[156:159], v[172:175], v[80:95]
  s_nop 10
  ds_write_b128 v140, v[32:35] offset:0
  ds_write_b128 v140, v[36:39] offset:1024
  ds_write_b128 v140, v[40:43] offset:2048
  ds_write_b128 v140, v[44:47] offset:3072
  ds_write_b128 v140, v[48:51] offset:4096
  ds_write_b128 v140, v[52:55] offset:5120
  ds_write_b128 v140, v[56:59] offset:6144
  ds_write_b128 v140, v[60:63] offset:7168
  ds_write_b128 v140, v[64:67] offset:8192
  ds_write_b128 v140, v[68:71] offset:9216
  ds_write_b128 v140, v[72:75] offset:10240
  ds_write_b128 v140, v[76:79] offset:11264
  ds_write_b128 v140, v[80:83] offset:12288
  ds_write_b128 v140, v[84:87] offset:13312
  ds_write_b128 v140, v[88:91] offset:14336
  ds_write_b128 v140, v[92:95] offset:15360
  s_waitcnt lgkmcnt(0)
  s_endpgm
L_P0:
  v_and_b32 v1, 31, v0
  s_lshl_b32 s42, s37, 5
  v_add_u32 v1, s42, v1
  v_lshrrev_b32 v2, 1, v1
  v_lshrrev_b32 v3, 5, v0
  v_xor_b32 v2, v2, v3
  v_and_b32 v2, 7, v2
  v_lshlrev_b32 v2, 4, v2
  v_lshl_add_u32 v4, v1, 7, v2
  v_xor_b32 v5, 32, v4
  v_xor_b32 v6, 64, v4
  v_xor_b32 v7, 96, v4
  v_lshrrev_b32 v1, 5, v0
  v_lshlrev_b32 v1, 3, v1
  v_bfe_u32 v2, v0, 2, 2
  v_add_u32 v1, v1, v2
  v_mul_u32_u24 v1, 192, v1
  v_and_b32 v2, 3, v0
  v_lshl_add_u32 v1, v2, 3, v1
  v_bfe_u32 v2, v0, 4, 1
  v_mul_u32_u24 v2, 32, v2
  v_add_u32 v8, v1, v2
  v_add_u32 v8, 16384, v8
  v_lshlrev_b32 v1, 2, v0
  v_min_u32 v1, 124, v1
  v_add_u32 v1, 163712, v1
  ds_write_b32 v1, v254 offset:0
  v_mov_b32 v9, 163712
  v_and_b32 v1, 31, v0
  v_lshrrev_b32 v2, 5, v0
  v_lshlrev_b32 v2, 2, v2
  v_sub_u32 v1, v1, v2
  v_mov_b32 v2, 0x3f80
  v_mov_b32 v3, 0x3f800000
  v_cmp_eq_u32 vcc, 0, v1
  s_nop 1
  v_cndmask_b32 v16, 0, v2, vcc
  v_cmp_eq_u32 vcc, 1, v1
  s_nop 1
  v_cndmask_b32 v16, v16, v3, vcc
  v_cmp_eq_u32 vcc, 2, v1
  s_nop 1
  v_cndmask_b32 v17, 0, v2, vcc
  v_cmp_eq_u32 vcc, 3, v1
  s_nop 1
  v_cndmask_b32 v17, v17, v3, vcc
  v_cmp_eq_u32 vcc, 8, v1
  s_nop 1
  v_cndmask_b32 v18, 0, v2, vcc
  v_cmp_eq_u32 vcc, 9, v1
  s_nop 1
  v_cndmask_b32 v18, v18, v3, vcc
  v_cmp_eq_u32 vcc, 10, v1
  s_nop 1
  v_cndmask_b32 v19, 0, v2, vcc
  v_cmp_eq_u32 vcc, 11, v1
  s_nop 1
  v_cndmask_b32 v19, v19, v3, vcc
  v_cmp_eq_u32 vcc, 16, v1
  s_nop 1
  v_cndmask_b32 v20, 0, v2, vcc
  v_cmp_eq_u32 vcc, 17, v1
  s_nop 1
  v_cndmask_b32 v20, v20, v3, vcc
  v_cmp_eq_u32 vcc, 18, v1
  s_nop 1
  v_cndmask_b32 v21, 0, v2, vcc
  v_cmp_eq_u32 vcc, 19, v1
  s_nop 1
  v_cndmask_b32 v21, v21, v3, vcc
  v_cmp_eq_u32 vcc, 24, v1
  s_nop 1
  v_cndmask_b32 v22, 0, v2, vcc
  v_cmp_eq_u32 vcc, 25, v1
  s_nop 1
  v_cndmask_b32 v22, v22, v3, vcc
  v_cmp_eq_u32 vcc, 26, v1
  s_nop 1
  v_cndmask_b32 v23, 0, v2, vcc
  v_cmp_eq_u32 vcc, 27, v1
  s_nop 1
  v_cndmask_b32 v23, v23, v3, vcc
  v_lshlrev_b32 v13, 4, v0
  v_and_b32 v1, 15, v0
  v_lshlrev_b32 v1, 4, v1
  v_lshrrev_b32 v2, 5, v0
  v_lshl_add_u32 v1, v2, 8, v1
  v_bfe_u32 v3, v0, 4, 1
  v_lshl_add_u32 v14, v3, 16, v1
  v_lshlrev_b32 v12, 4, v2
  v_add_u32 v12, 159744, v12
  s_waitcnt lgkmcnt(0)
  s_lshl_b32 s42, s39, 17
  s_add_u32 s24, s4, s42
  s_addc_u32 s25, s5, 0
  s_mov_b32 s26, 131072
  s_mov_b32 s27, 131072
  s_mov_b32 s28, s6
  s_mov_b32 s29, s7
  s_mov_b32 s30, 1572864
  s_mov_b32 s31, 131072
  s_mov_b32 s32, s22
  s_mov_b32 s33, s23
  s_mov_b32 s34, 15073280
  s_mov_b32 s35, 131072
  s_mov_b32 s56, s20
  s_mov_b32 s57, s21
  s_mov_b32 s58, 256
  s_mov_b32 s59, 131072
  s_cmp_lt_u32 s37, 2
  s_cselect_b32 s52, s12, s14
  s_cselect_b32 s53, s13, s15
  s_cmp_lt_u32 s40, 15
  s_cselect_b32 s54, 1409024, 0
  s_mov_b32 s55, 131072
  s_and_b32 s50, s37, 1
  s_mul_i32 s62, s50, 6144
  s_lshr_b32 s51, s37, 1
  s_mul_i32 s51, s51, 12320
  s_add_u32 s62, s62, s51
  s_mul_i32 s50, s50, 88064
  s_lshl_b32 s51, s63, 5
  s_add_u32 s50, s50, s51
  v_add_u32 v1, 0, v0
  v_mul_u32_u24 v2, 5462, v1
  v_lshrrev_b32 v2, 16, v2
  v_mul_u32_u24 v2, 2560, v2
  v_lshl_add_u32 v2, v1, 4, v2
  s_sub_u32 s48, s50, 0
  v_add_u32 v244, s48, v2
  v_add_u32 v1, 64, v0
  v_mul_u32_u24 v2, 5462, v1
  v_lshrrev_b32 v2, 16, v2
  v_mul_u32_u24 v2, 2560, v2
  v_lshl_add_u32 v2, v1, 4, v2
  s_sub_u32 s48, s50, 1024
  v_add_u32 v245, s48, v2
  v_add_u32 v1, 128, v0
  v_mul_u32_u24 v2, 5462, v1
  v_lshrrev_b32 v2, 16, v2
  v_mul_u32_u24 v2, 2560, v2
  v_lshl_add_u32 v2, v1, 4, v2
  s_sub_u32 s48, s50, 2048
  v_add_u32 v246, s48, v2
  v_add_u32 v1, 192, v0
  v_mul_u32_u24 v2, 5462, v1
  v_lshrrev_b32 v2, 16, v2
  v_mul_u32_u24 v2, 2560, v2
  v_lshl_add_u32 v2, v1, 4, v2
  s_sub_u32 s48, s50, 3072
  v_add_u32 v247, s48, v2
  v_add_u32 v1, 256, v0
  v_mul_u32_u24 v2, 5462, v1
  v_lshrrev_b32 v2, 16, v2
  v_mul_u32_u24 v2, 2560, v2
  v_lshl_add_u32 v2, v1, 4, v2
  s_sub_u32 s48, s50, 0
  v_add_u32 v248, s48, v2
  v_add_u32 v1, 320, v0
  v_mul_u32_u24 v2, 5462, v1
  v_lshrrev_b32 v2, 16, v2
  v_mul_u32_u24 v2, 2560, v2
  v_lshl_add_u32 v2, v1, 4, v2
  s_sub_u32 s48, s50, 1024
  v_add_u32 v249, s48, v2
  v_add_u32 v15, 57344, v8
  s_waitcnt lgkmcnt(0)
  s_barrier
  ds_read_b128 v[24:27], v4 offset:0
  ds_read_b64_tr_b16 v[36:37], v8 offset:0
  ds_read_b64_tr_b16 v[38:39], v8 offset:768
  ds_read_b64_tr_b16 v[40:41], v8 offset:64
  ds_read_b64_tr_b16 v[42:43], v8 offset:832
  ds_read_b64_tr_b16 v[44:45], v8 offset:128
  ds_read_b64_tr_b16 v[46:47], v8 offset:896
  ds_read_b128 v[28:31], v5 offset:0
  ds_read_b64_tr_b16 v[48:49], v8 offset:3072
  ds_read_b64_tr_b16 v[50:51], v8 offset:3840
  ds_read_b64_tr_b16 v[52:53], v8 offset:3136
  ds_read_b64_tr_b16 v[54:55], v8 offset:3904
  ds_read_b64_tr_b16 v[56:57], v8 offset:3200
  ds_read_b64_tr_b16 v[58:59], v8 offset:3968
  ds_read_b128 v[32:35], v6 offset:0
  ds_read_b64_tr_b16 v[60:61], v8 offset:6144
  ds_read_b64_tr_b16 v[62:63], v8 offset:6912
  s_waitcnt lgkmcnt(14)
  v_mfma_f32_32x32x16_bf16 v[72:87], v[36:39], v[24:27], 0
  ds_read_b64_tr_b16 v[64:65], v8 offset:6208
  ds_read_b64_tr_b16 v[66:67], v8 offset:6976
  s_waitcnt lgkmcnt(14)
  v_mfma_f32_32x32x16_bf16 v[88:103], v[40:43], v[24:27], 0
  ds_read_b64_tr_b16 v[68:69], v8 offset:6272
  ds_read_b64_tr_b16 v[70:71], v8 offset:7040
  s_waitcnt lgkmcnt(14)
  v_mfma_f32_32x32x16_bf16 v[104:119], v[44:47], v[24:27], 0
  s_cmp_lg_u32 s37, 0
  s_cbranch_scc1 np_6220_3001
  buffer_load_dwordx2 v[252:253], v254, s[56:59], 0 offen sc1
np_6220_3001:
  s_lshl_b32 s42, s40, 13
  s_lshl_b32 s43, s37, 11
  s_add_u32 s42, s42, s43
  v_lshlrev_b32 v200, 5, v0
  buffer_load_dwordx4 v[152:155], v200, s[24:27], s42 offen
  buffer_load_dwordx4 v[156:159], v200, s[24:27], s42 offen offset:16
  s_lshr_b32 s42, s39, 2
  s_and_b32 s43, s39, 3
  s_cmp_eq_u32 s42, 1
  s_cselect_b32 s44, s12, s14
  s_cselect_b32 s45, s13, s15
  s_movk_i32 s49, 2752
  s_lshl_b32 s50, s63, 5
  s_mul_i32 s51, s40, 192
  s_cmp_eq_u32 s42, 0
  s_cselect_b32 s44, s6, s44
  s_cselect_b32 s45, s7, s45
  s_cselect_b32 s49, 3072, s49
  s_cselect_b32 s50, s51, s50
  s_lshl_b32 s46, s49, 9
  s_cmp_eq_u32 s42, 3
  s_cselect_b32 s46, 0, s46
  s_mov_b32 s47, 131072
  s_lshl_b32 s51, s43, 2
  s_add_u32 s51, s51, s37
  s_lshl_b32 s51, s51, 5
  s_mul_i32 s51, s51, s49
  s_add_u32 s50, s50, s51
  v_lshrrev_b32 v200, 4, v0
  v_mul_u32_u24 v200, s49, v200
  v_and_b32 v201, 15, v0
  v_lshl_add_u32 v200, v201, 4, v200
  v_cmp_gt_u32 vcc, 12, v201
  v_mov_b32 v201, 0x40000000
  s_nop 0
  v_cndmask_b32 v200, v201, v200, vcc
  s_lshl_b32 s49, s49, 2
  buffer_load_dwordx4 v[160:163], v200, s[44:47], s50 offen
  s_add_u32 s50, s50, s49
  buffer_load_dwordx4 v[164:167], v200, s[44:47], s50 offen
  s_add_u32 s50, s50, s49
  buffer_load_dwordx4 v[168:171], v200, s[44:47], s50 offen
  s_add_u32 s50, s50, s49
  buffer_load_dwordx4 v[172:175], v200, s[44:47], s50 offen
  s_add_u32 s50, s50, s49
  buffer_load_dwordx4 v[176:179], v200, s[44:47], s50 offen
  s_add_u32 s50, s50, s49
  buffer_load_dwordx4 v[180:183], v200, s[44:47], s50 offen
  s_add_u32 s50, s50, s49
  buffer_load_dwordx4 v[184:187], v200, s[44:47], s50 offen
  s_add_u32 s50, s50, s49
  buffer_load_dwordx4 v[188:191], v200, s[44:47], s50 offen
  s_lshl_b32 s96, s40, 2
  s_add_u32 s96, s96, s43
  s_lshl_b32 s96, s96, 12
  s_lshl_b32 s50, s42, 7
  s_add_u32 s50, s50, 640
  s_cmp_eq_u32 s42, 0
  s_cselect_b32 s50, 0, s50
  s_add_u32 s96, s96, s50
  s_add_u32 s96, s96, 14811136
  ds_read_b128 v[24:27], v7 offset:0
  ds_read_b64_tr_b16 v[36:37], v8 offset:9216
  ds_read_b64_tr_b16 v[38:39], v8 offset:9984
  s_waitcnt lgkmcnt(14)
  v_mfma_f32_32x32x16_bf16 v[72:87], v[48:51], v[28:31], v[72:87]
  ds_read_b64_tr_b16 v[40:41], v8 offset:9280
  ds_read_b64_tr_b16 v[42:43], v8 offset:10048
  s_waitcnt lgkmcnt(14)
  v_mfma_f32_32x32x16_bf16 v[88:103], v[52:55], v[28:31], v[88:103]
  ds_read_b64_tr_b16 v[44:45], v8 offset:9344
  ds_read_b64_tr_b16 v[46:47], v8 offset:10112
  s_waitcnt lgkmcnt(14)
  v_mfma_f32_32x32x16_bf16 v[104:119], v[56:59], v[28:31], v[104:119]
  s_waitcnt lgkmcnt(0)
  s_barrier
  ds_read_b128 v[28:31], v4 offset:28672
  ds_read_b64_tr_b16 v[48:49], v8 offset:28672
  ds_read_b64_tr_b16 v[50:51], v8 offset:29440
  v_mfma_f32_32x32x16_bf16 v[72:87], v[60:63], v[32:35], v[72:87]
  ds_read_b64_tr_b16 v[52:53], v8 offset:28736
  ds_read_b64_tr_b16 v[54:55], v8 offset:29504
  v_mfma_f32_32x32x16_bf16 v[88:103], v[64:67], v[32:35], v[88:103]
  ds_read_b64_tr_b16 v[56:57], v8 offset:28800
  ds_read_b64_tr_b16 v[58:59], v8 offset:29568
  v_mfma_f32_32x32x16_bf16 v[104:119], v[68:71], v[32:35], v[104:119]
  ds_read_b128 v[32:35], v5 offset:28672
  ds_read_b64_tr_b16 v[60:61], v8 offset:31744
  ds_read_b64_tr_b16 v[62:63], v8 offset:32512
  v_mfma_f32_32x32x16_bf16 v[72:87], v[36:39], v[24:27], v[72:87]
  s_waitcnt vmcnt(8)
  v_lshlrev_b32 v200, 16, v152
  v_and_b32 v201, 0xffff0000, v152
  v_add_f32 v250, v200, v201
  v_mul_f32 v251, v200, v200
  v_fmac_f32 v251, v201, v201
  v_lshlrev_b32 v200, 16, v153
  ds_read_b64_tr_b16 v[64:65], v8 offset:31808
  ds_read_b64_tr_b16 v[66:67], v8 offset:32576
  v_mfma_f32_32x32x16_bf16 v[88:103], v[40:43], v[24:27], v[88:103]
  v_and_b32 v201, 0xffff0000, v153
  v_add_f32 v250, v250, v200
  v_fmac_f32 v251, v200, v200
  v_add_f32 v250, v250, v201
  v_fmac_f32 v251, v201, v201
  v_lshlrev_b32 v200, 16, v154
  v_and_b32 v201, 0xffff0000, v154
  ds_read_b64_tr_b16 v[68:69], v8 offset:31872
  ds_read_b64_tr_b16 v[70:71], v8 offset:32640
  v_mfma_f32_32x32x16_bf16 v[104:119], v[44:47], v[24:27], v[104:119]
  v_add_f32 v250, v250, v200
  v_fmac_f32 v251, v200, v200
  v_add_f32 v250, v250, v201
  v_fmac_f32 v251, v201, v201
  v_lshlrev_b32 v200, 16, v155
  v_and_b32 v201, 0xffff0000, v155
  v_add_f32 v250, v250, v200
  ds_read_b128 v[24:27], v6 offset:28672
  ds_read_b64_tr_b16 v[36:37], v8 offset:34816
  ds_read_b64_tr_b16 v[38:39], v8 offset:35584
  s_waitcnt lgkmcnt(14)
  v_mfma_f32_32x32x16_bf16 v[72:87], v[48:51], v[28:31], v[72:87]
  v_fmac_f32 v251, v200, v200
  v_add_f32 v250, v250, v201
  v_fmac_f32 v251, v201, v201
  v_lshlrev_b32 v200, 16, v156
  v_and_b32 v201, 0xffff0000, v156
  v_add_f32 v250, v250, v200
  v_fmac_f32 v251, v200, v200
  ds_read_b64_tr_b16 v[40:41], v8 offset:34880
  ds_read_b64_tr_b16 v[42:43], v8 offset:35648
  s_waitcnt lgkmcnt(14)
  v_mfma_f32_32x32x16_bf16 v[88:103], v[52:55], v[28:31], v[88:103]
  v_add_f32 v250, v250, v201
  v_fmac_f32 v251, v201, v201
  v_lshlrev_b32 v200, 16, v157
  v_and_b32 v201, 0xffff0000, v157
  v_add_f32 v250, v250, v200
  v_fmac_f32 v251, v200, v200
  v_add_f32 v250, v250, v201
  ds_read_b64_tr_b16 v[44:45], v8 offset:34944
  ds_read_b64_tr_b16 v[46:47], v8 offset:35712
  s_waitcnt lgkmcnt(14)
  v_mfma_f32_32x32x16_bf16 v[104:119], v[56:59], v[28:31], v[104:119]
  v_fmac_f32 v251, v201, v201
  v_lshlrev_b32 v200, 16, v158
  v_and_b32 v201, 0xffff0000, v158
  v_add_f32 v250, v250, v200
  v_fmac_f32 v251, v200, v200
  v_add_f32 v250, v250, v201
  v_fmac_f32 v251, v201, v201
  ds_read_b128 v[28:31], v7 offset:28672
  ds_read_b64_tr_b16 v[48:49], v8 offset:37888
  ds_read_b64_tr_b16 v[50:51], v8 offset:38656
  s_waitcnt lgkmcnt(14)
  v_mfma_f32_32x32x16_bf16 v[72:87], v[60:63], v[32:35], v[72:87]
  v_lshlrev_b32 v200, 16, v159
  v_and_b32 v201, 0xffff0000, v159
  v_add_f32 v250, v250, v200
  v_fmac_f32 v251, v200, v200
  v_add_f32 v250, v250, v201
  v_fmac_f32 v251, v201, v201
  s_nop 1
  v_permlane16_swap_b32 v250, v251
  ds_read_b64_tr_b16 v[52:53], v8 offset:37952
  ds_read_b64_tr_b16 v[54:55], v8 offset:38720
  s_waitcnt lgkmcnt(14)
  v_mfma_f32_32x32x16_bf16 v[88:103], v[64:67], v[32:35], v[88:103]
  v_add_f32 v250, v250, v251
  s_nop 1
  v_add_f32_dpp v250, v250, v250 row_ror:8 row_mask:0xf bank_mask:0xf
  s_nop 1
  v_add_f32_dpp v250, v250, v250 row_ror:4 row_mask:0xf bank_mask:0xf
  s_nop 1
  v_add_f32_dpp v250, v250, v250 row_ror:2 row_mask:0xf bank_mask:0xf
  s_nop 1
  v_add_f32_dpp v250, v250, v250 row_ror:1 row_mask:0xf bank_mask:0xf
  v_mov_b32 v251, v250
  s_nop 1
  v_permlane16_swap_b32 v250, v251
  ds_read_b64_tr_b16 v[56:57], v8 offset:38016
  ds_read_b64_tr_b16 v[58:59], v8 offset:38784
  s_waitcnt lgkmcnt(14)
  v_mfma_f32_32x32x16_bf16 v[104:119], v[68:71], v[32:35], v[104:119]
  v_mul_f32 v250, 0x3b000000, v250
  v_mul_f32 v251, 0x3b000000, v251
  v_fma_f32 v251, -v250, v250, v251
  v_max_f32 v251, 0, v251
  v_cvt_pk_bf16_f32 v251, v251, v251
  v_lshlrev_b32 v251, 16, v251
  v_add_f32 v251, 0x3727c5ac, v251
  v_cvt_pk_bf16_f32 v251, v251, v251
  v_lshlrev_b32 v251, 16, v251
  s_waitcnt lgkmcnt(0)
  s_barrier
  ds_read_b128 v[32:35], v4 offset:57344
  ds_read_b64_tr_b16 v[60:61], v8 offset:57344
  ds_read_b64_tr_b16 v[62:63], v8 offset:58112
  v_mfma_f32_32x32x16_bf16 v[72:87], v[36:39], v[24:27], v[72:87]
  v_sqrt_f32 v251, v251
  s_nop 0
  v_cvt_pk_bf16_f32 v251, v251, v251
  v_lshlrev_b32 v251, 16, v251
  v_rcp_f32 v251, v251
  v_cvt_pk_bf16_f32 v250, v250, v250
  v_lshlrev_b32 v250, 16, v250
  v_sub_f32 v250, 0, v250
  s_waitcnt vmcnt(0)
  v_lshlrev_b32 v192, 16, v160
  ds_read_b64_tr_b16 v[64:65], v8 offset:57408
  ds_read_b64_tr_b16 v[66:67], v8 offset:58176
  v_mfma_f32_32x32x16_bf16 v[88:103], v[40:43], v[24:27], v[88:103]
  v_and_b32 v193, 0xffff0000, v160
  v_lshlrev_b32 v194, 16, v161
  v_and_b32 v195, 0xffff0000, v161
  v_lshlrev_b32 v196, 16, v162
  v_and_b32 v197, 0xffff0000, v162
  v_lshlrev_b32 v198, 16, v163
  v_and_b32 v199, 0xffff0000, v163
  ds_read_b64_tr_b16 v[68:69], v8 offset:57472
  ds_read_b64_tr_b16 v[70:71], v8 offset:58240
  v_mfma_f32_32x32x16_bf16 v[104:119], v[44:47], v[24:27], v[104:119]
  v_lshlrev_b32 v200, 16, v164
  v_and_b32 v201, 0xffff0000, v164
  v_add_f32 v192, v192, v200
  v_add_f32 v193, v193, v201
  v_lshlrev_b32 v200, 16, v165
  v_and_b32 v201, 0xffff0000, v165
  v_add_f32 v194, v194, v200
  ds_read_b128 v[24:27], v5 offset:57344
  ds_read_b64_tr_b16 v[36:37], v8 offset:60416
  ds_read_b64_tr_b16 v[38:39], v8 offset:61184
  v_mfma_f32_32x32x16_bf16 v[72:87], v[48:51], v[28:31], v[72:87]
  v_add_f32 v195, v195, v201
  v_lshlrev_b32 v200, 16, v166
  v_and_b32 v201, 0xffff0000, v166
  v_add_f32 v196, v196, v200
  v_add_f32 v197, v197, v201
  v_lshlrev_b32 v200, 16, v167
  v_and_b32 v201, 0xffff0000, v167
  ds_read_b64_tr_b16 v[40:41], v8 offset:60480
  ds_read_b64_tr_b16 v[42:43], v8 offset:61248
  v_mfma_f32_32x32x16_bf16 v[88:103], v[52:55], v[28:31], v[88:103]
  v_add_f32 v198, v198, v200
  v_add_f32 v199, v199, v201
  v_lshlrev_b32 v200, 16, v168
  v_and_b32 v201, 0xffff0000, v168
  v_add_f32 v192, v192, v200
  v_add_f32 v193, v193, v201
  v_lshlrev_b32 v200, 16, v169
  ds_read_b64_tr_b16 v[44:45], v8 offset:60544
  ds_read_b64_tr_b16 v[46:47], v8 offset:61312
  v_mfma_f32_32x32x16_bf16 v[104:119], v[56:59], v[28:31], v[104:119]
  v_and_b32 v201, 0xffff0000, v169
  v_add_f32 v194, v194, v200
  v_add_f32 v195, v195, v201
  v_lshlrev_b32 v200, 16, v170
  v_and_b32 v201, 0xffff0000, v170
  v_add_f32 v196, v196, v200
  v_add_f32 v197, v197, v201
  ds_read_b128 v[28:31], v6 offset:57344
  ds_read_b64_tr_b16 v[48:49], v8 offset:63488
  ds_read_b64_tr_b16 v[50:51], v8 offset:64256
  s_waitcnt lgkmcnt(14)
  v_mfma_f32_32x32x16_bf16 v[72:87], v[60:63], v[32:35], v[72:87]
  v_lshlrev_b32 v200, 16, v171
  v_and_b32 v201, 0xffff0000, v171
  v_add_f32 v198, v198, v200
  v_add_f32 v199, v199, v201
  v_lshlrev_b32 v200, 16, v172
  v_and_b32 v201, 0xffff0000, v172
  v_add_f32 v192, v192, v200
  ds_read_b64_tr_b16 v[52:53], v8 offset:63552
  ds_read_b64_tr_b16 v[54:55], v8 offset:64320
  s_waitcnt lgkmcnt(14)
  v_mfma_f32_32x32x16_bf16 v[88:103], v[64:67], v[32:35], v[88:103]
  v_add_f32 v193, v193, v201
  v_lshlrev_b32 v200, 16, v173
  v_and_b32 v201, 0xffff0000, v173
  v_add_f32 v194, v194, v200
  v_add_f32 v195, v195, v201
  v_lshlrev_b32 v200, 16, v174
  v_and_b32 v201, 0xffff0000, v174
  ds_read_b64_tr_b16 v[56:57], v8 offset:63616
  ds_read_b64_tr_b16 v[58:59], v8 offset:64384
  s_waitcnt lgkmcnt(14)
  v_mfma_f32_32x32x16_bf16 v[104:119], v[68:71], v[32:35], v[104:119]
  v_add_f32 v196, v196, v200
  v_add_f32 v197, v197, v201
  v_lshlrev_b32 v200, 16, v175
  v_and_b32 v201, 0xffff0000, v175
  v_add_f32 v198, v198, v200
  v_add_f32 v199, v199, v201
  v_lshlrev_b32 v200, 16, v176
  ds_read_b128 v[32:35], v7 offset:57344
  ds_read_b64_tr_b16 v[60:61], v15 offset:9216
  ds_read_b64_tr_b16 v[62:63], v15 offset:9984
  s_waitcnt lgkmcnt(14)
  v_mfma_f32_32x32x16_bf16 v[72:87], v[36:39], v[24:27], v[72:87]
  v_and_b32 v201, 0xffff0000, v176
  v_add_f32 v192, v192, v200
  v_add_f32 v193, v193, v201
  v_lshlrev_b32 v200, 16, v177
  v_and_b32 v201, 0xffff0000, v177
  v_add_f32 v194, v194, v200
  v_add_f32 v195, v195, v201
  ds_read_b64_tr_b16 v[64:65], v15 offset:9280
  ds_read_b64_tr_b16 v[66:67], v15 offset:10048
  s_waitcnt lgkmcnt(14)
  v_mfma_f32_32x32x16_bf16 v[88:103], v[40:43], v[24:27], v[88:103]
  v_lshlrev_b32 v200, 16, v178
  v_and_b32 v201, 0xffff0000, v178
  v_add_f32 v196, v196, v200
  v_add_f32 v197, v197, v201
  v_lshlrev_b32 v200, 16, v179
  v_and_b32 v201, 0xffff0000, v179
  v_add_f32 v198, v198, v200
  ds_read_b64_tr_b16 v[68:69], v15 offset:9344
  ds_read_b64_tr_b16 v[70:71], v15 offset:10112
  s_waitcnt lgkmcnt(14)
  v_mfma_f32_32x32x16_bf16 v[104:119], v[44:47], v[24:27], v[104:119]
  v_add_f32 v199, v199, v201
  v_lshlrev_b32 v200, 16, v180
  v_and_b32 v201, 0xffff0000, v180
  v_add_f32 v192, v192, v200
  v_add_f32 v193, v193, v201
  v_lshlrev_b32 v200, 16, v181
  v_and_b32 v201, 0xffff0000, v181
  s_waitcnt lgkmcnt(0)
  s_barrier
  ds_read_b128 v[24:27], v4 offset:0
  ds_read_b64_tr_b16 v[36:37], v8 offset:0
  ds_read_b64_tr_b16 v[38:39], v8 offset:768
  v_mfma_f32_32x32x16_bf16 v[72:87], v[48:51], v[28:31], v[72:87]
  v_add_f32 v194, v194, v200
  v_add_f32 v195, v195, v201
  v_lshlrev_b32 v200, 16, v182
  v_and_b32 v201, 0xffff0000, v182
  v_add_f32 v196, v196, v200
  v_add_f32 v197, v197, v201
  v_lshlrev_b32 v200, 16, v183
  ds_read_b64_tr_b16 v[40:41], v8 offset:64
  ds_read_b64_tr_b16 v[42:43], v8 offset:832
  v_mfma_f32_32x32x16_bf16 v[88:103], v[52:55], v[28:31], v[88:103]
  v_and_b32 v201, 0xffff0000, v183
  v_add_f32 v198, v198, v200
  v_add_f32 v199, v199, v201
  v_lshlrev_b32 v200, 16, v184
  v_and_b32 v201, 0xffff0000, v184
  v_add_f32 v192, v192, v200
  v_add_f32 v193, v193, v201
  ds_read_b64_tr_b16 v[44:45], v8 offset:128
  ds_read_b64_tr_b16 v[46:47], v8 offset:896
  v_mfma_f32_32x32x16_bf16 v[104:119], v[56:59], v[28:31], v[104:119]
  v_lshlrev_b32 v200, 16, v185
  v_and_b32 v201, 0xffff0000, v185
  v_add_f32 v194, v194, v200
  v_add_f32 v195, v195, v201
  v_lshlrev_b32 v200, 16, v186
  v_and_b32 v201, 0xffff0000, v186
  v_add_f32 v196, v196, v200
  ds_read_b128 v[28:31], v5 offset:0
  ds_read_b64_tr_b16 v[48:49], v8 offset:3072
  ds_read_b64_tr_b16 v[50:51], v8 offset:3840
  v_mfma_f32_32x32x16_bf16 v[72:87], v[60:63], v[32:35], v[72:87]
  v_add_f32 v197, v197, v201
  v_lshlrev_b32 v200, 16, v187
  v_and_b32 v201, 0xffff0000, v187
  v_add_f32 v198, v198, v200
  v_add_f32 v199, v199, v201
  v_lshlrev_b32 v200, 16, v188
  v_and_b32 v201, 0xffff0000, v188
  ds_read_b64_tr_b16 v[52:53], v8 offset:3136
  ds_read_b64_tr_b16 v[54:55], v8 offset:3904
  v_mfma_f32_32x32x16_bf16 v[88:103], v[64:67], v[32:35], v[88:103]
  v_add_f32 v192, v192, v200
  v_add_f32 v193, v193, v201
  v_lshlrev_b32 v200, 16, v189
  v_and_b32 v201, 0xffff0000, v189
  v_add_f32 v194, v194, v200
  v_add_f32 v195, v195, v201
  v_lshlrev_b32 v200, 16, v190
  ds_read_b64_tr_b16 v[56:57], v8 offset:3200
  ds_read_b64_tr_b16 v[58:59], v8 offset:3968
  v_mfma_f32_32x32x16_bf16 v[104:119], v[68:71], v[32:35], v[104:119]
  v_and_b32 v201, 0xffff0000, v190
  v_add_f32 v196, v196, v200
  v_add_f32 v197, v197, v201
  v_lshlrev_b32 v200, 16, v191
  v_and_b32 v201, 0xffff0000, v191
  v_add_f32 v198, v198, v200
  v_add_f32 v199, v199, v201
  ds_read_b128 v[32:35], v6 offset:0
  ds_read_b64_tr_b16 v[60:61], v8 offset:6144
  ds_read_b64_tr_b16 v[62:63], v8 offset:6912
  s_waitcnt lgkmcnt(14)
  v_mfma_f32_32x32x16_bf16 v[72:87], v[36:39], v[24:27], v[72:87]
  v_permlane32_swap_b32 v192, v193
  v_permlane32_swap_b32 v194, v195
  v_permlane32_swap_b32 v196, v197
  v_permlane32_swap_b32 v198, v199
  v_add_f32 v192, v192, v193
  v_add_f32 v194, v194, v195
  v_add_f32 v196, v196, v197
  ds_read_b64_tr_b16 v[64:65], v8 offset:6208
  ds_read_b64_tr_b16 v[66:67], v8 offset:6976
  s_waitcnt lgkmcnt(14)
  v_mfma_f32_32x32x16_bf16 v[88:103], v[40:43], v[24:27], v[88:103]
  v_add_f32 v198, v198, v199
  v_permlane16_swap_b32 v192, v194
  s_nop 0
  v_permlane16_swap_b32 v196, v198
  v_add_f32 v192, v192, v194
  v_add_f32 v196, v196, v198
  v_and_b32 v200, 15, v0
  v_lshlrev_b32 v200, 5, v200
  ds_read_b64_tr_b16 v[68:69], v8 offset:6272
  ds_read_b64_tr_b16 v[70:71], v8 offset:7040
  s_waitcnt lgkmcnt(14)
  v_mfma_f32_32x32x16_bf16 v[104:119], v[44:47], v[24:27], v[104:119]
  v_bfe_u32 v201, v0, 4, 1
  v_lshl_add_u32 v200, v201, 3, v200
  v_lshrrev_b32 v201, 5, v0
  v_lshl_add_u32 v200, v201, 2, v200
  s_lshl_b32 s50, s37, 9
  s_add_u32 s50, s50, 155648
  v_add_u32 v200, s50, v200
  ds_write_b32 v200, v192 offset:0
  ds_write_b32 v200, v196 offset:16
  ds_read_b128 v[24:27], v7 offset:0
  ds_read_b64_tr_b16 v[36:37], v8 offset:9216
  ds_read_b64_tr_b16 v[38:39], v8 offset:9984
  s_waitcnt lgkmcnt(15)
  v_mfma_f32_32x32x16_bf16 v[72:87], v[48:51], v[28:31], v[72:87]
  s_cmp_lg_u32 s37, 0
  s_cbranch_scc1 nsk_6220_3004
nlp_6220_3003:
  v_cmp_eq_u32 vcc, 0, v253
  s_nop 4
  s_cbranch_vccz nok_6220_3002
  s_add_u32 s3, s3, 1
  s_cmp_gt_u32 s3, 4194304
  s_cbranch_scc1 nok_6220_3002
  s_sleep 4
  buffer_load_dwordx2 v[252:253], v254, s[56:59], 0 offen sc1
  s_waitcnt vmcnt(0)
  s_branch nlp_6220_3003
nok_6220_3002:
  v_mov_b32 v200, 163696
  ds_write_b64 v200, v[252:253] offset:0
nsk_6220_3004:
  ds_read_b64_tr_b16 v[40:41], v8 offset:9280
  ds_read_b64_tr_b16 v[42:43], v8 offset:10048
  s_waitcnt lgkmcnt(15)
  v_mfma_f32_32x32x16_bf16 v[88:103], v[52:55], v[28:31], v[88:103]
  ds_read_b64_tr_b16 v[44:45], v8 offset:9344
  ds_read_b64_tr_b16 v[46:47], v8 offset:10112
  s_waitcnt lgkmcnt(15)
  v_mfma_f32_32x32x16_bf16 v[104:119], v[56:59], v[28:31], v[104:119]
  s_waitcnt lgkmcnt(0)
  s_barrier
  ds_read_b128 v[28:31], v4 offset:28672
  ds_read_b64_tr_b16 v[48:49], v8 offset:28672
  ds_read_b64_tr_b16 v[50:51], v8 offset:29440
  v_mfma_f32_32x32x16_bf16 v[72:87], v[60:63], v[32:35], v[72:87]
  ds_read_b64_tr_b16 v[52:53], v8 offset:28736
  ds_read_b64_tr_b16 v[54:55], v8 offset:29504
  v_mfma_f32_32x32x16_bf16 v[88:103], v[64:67], v[32:35], v[88:103]
  ds_read_b64_tr_b16 v[56:57], v8 offset:28800
  ds_read_b64_tr_b16 v[58:59], v8 offset:29568
  v_mfma_f32_32x32x16_bf16 v[104:119], v[68:71], v[32:35], v[104:119]
  v_mov_b32 v200, 163696
  ds_read_b64 v[252:253], v200 offset:0
  s_lshl_b32 s50, s39, 11
  s_lshl_b32 s51, s40, 7
  s_add_u32 s50, s50, s51
  s_lshl_b32 s51, s37, 5
  s_add_u32 s50, s50, s51
  s_add_u32 s50, s50, 14778368
  v_lshrrev_b32 v201, 1, v0
  s_waitcnt lgkmcnt(0)
  s_mov_b32 exec_lo, 1
  s_mov_b32 exec_hi, 1
  buffer_store_dwordx4 v[250:253], v201, s[32:35], s50 offen sc1
  s_mov_b64 exec, -1
  s_cmp_lg_u32 s37, 3
  s_cbranch_scc1 cf_6220_3005
  s_cmp_ge_u32 s39, 12
  s_cbranch_scc1 cf_6220_3005
  v_lshlrev_b32 v201, 3, v0
  v_add_u32 v201, 155648, v201
  ds_read_b64 v[160:161], v201 offset:0
  ds_read_b64 v[162:163], v201 offset:512
  ds_read_b64 v[164:165], v201 offset:1024
  ds_read_b64 v[166:167], v201 offset:1536
  v_lshrrev_b32 v201, 3, v0
  v_lshlrev_b32 v201, 3, v201
  s_cmp_lt_u32 s39, 4
  s_cselect_b32 s50, 0, -1
  v_and_b32 v201, s50, v201
  v_add_u32 v200, v0, v201
  v_lshlrev_b32 v200, 4, v200
  s_waitcnt lgkmcnt(0)
  v_add_f32 v250, v160, v162
  v_add_f32 v164, v164, v166
  v_add_f32 v250, v250, v164
  v_add_f32 v251, v161, v163
  v_add_f32 v165, v165, v167
  v_add_f32 v251, v251, v165
  s_mov_b32 exec_hi, 0xffff
  buffer_store_dwordx4 v[250:253], v200, s[32:35], s96 offen sc1
  s_mov_b32 exec_hi, -1
cf_6220_3005:
  s_lshl_b32 s50, s37, 6
  v_add_u32 v200, s50, v0
  v_mov_b32 v201, 144
  v_cmp_lt_u32 s[64:65], v200, v201
  s_lshl_b32 s50, s40, 14
  s_add_u32 s50, s50, 14811136
  v_lshl_add_u32 v200, v200, 4, s50
  v_mov_b32 v201, 0x40000000
  v_cndmask_b32 v236, v201, v200, s[64:65]
  v_add_u32 v237, 4096, v236
  v_add_u32 v238, 8192, v236
  v_add_u32 v239, 12288, v236
  s_lshl_b32 s50, s39, 11
  s_lshl_b32 s51, s37, 9
  s_add_u32 s50, s50, s51
  s_add_u32 s50, s50, 14778368
  v_and_b32 v200, 31, v0
  v_lshl_add_u32 v240, v200, 4, s50
  ds_read_b128 v[32:35], v5 offset:28672
  ds_read_b64_tr_b16 v[60:61], v8 offset:31744
  ds_read_b64_tr_b16 v[62:63], v8 offset:32512
  v_mfma_f32_32x32x16_bf16 v[72:87], v[36:39], v[24:27], v[72:87]
  ds_read_b64_tr_b16 v[64:65], v8 offset:31808
  ds_read_b64_tr_b16 v[66:67], v8 offset:32576
  v_mfma_f32_32x32x16_bf16 v[88:103], v[40:43], v[24:27], v[88:103]
  ds_read_b64_tr_b16 v[68:69], v8 offset:31872
  ds_read_b64_tr_b16 v[70:71], v8 offset:32640
  v_mfma_f32_32x32x16_bf16 v[104:119], v[44:47], v[24:27], v[104:119]
  ds_read_b128 v[24:27], v6 offset:28672
  ds_read_b64_tr_b16 v[36:37], v8 offset:34816
  ds_read_b64_tr_b16 v[38:39], v8 offset:35584
  v_mfma_f32_32x32x16_bf16 v[72:87], v[48:51], v[28:31], v[72:87]
  ds_read_b64_tr_b16 v[40:41], v8 offset:34880
  ds_read_b64_tr_b16 v[42:43], v8 offset:35648
  v_mfma_f32_32x32x16_bf16 v[88:103], v[52:55], v[28:31], v[88:103]
  ds_read_b64_tr_b16 v[44:45], v8 offset:34944
  ds_read_b64_tr_b16 v[46:47], v8 offset:35712
  v_mfma_f32_32x32x16_bf16 v[104:119], v[56:59], v[28:31], v[104:119]
  ds_read_b128 v[28:31], v7 offset:28672
  ds_read_b64_tr_b16 v[48:49], v8 offset:37888
  ds_read_b64_tr_b16 v[50:51], v8 offset:38656
  s_waitcnt lgkmcnt(14)
  v_mfma_f32_32x32x16_bf16 v[72:87], v[60:63], v[32:35], v[72:87]
  ds_read_b64_tr_b16 v[52:53], v8 offset:37952
  ds_read_b64_tr_b16 v[54:55], v8 offset:38720
  s_waitcnt lgkmcnt(14)
  v_mfma_f32_32x32x16_bf16 v[88:103], v[64:67], v[32:35], v[88:103]
  ds_read_b64_tr_b16 v[56:57], v8 offset:38016
  ds_read_b64_tr_b16 v[58:59], v8 offset:38784
  s_waitcnt lgkmcnt(14)
  v_mfma_f32_32x32x16_bf16 v[104:119], v[68:71], v[32:35], v[104:119]
  s_waitcnt lgkmcnt(0)
  s_barrier
  ds_read_b128 v[32:35], v4 offset:57344
  ds_read_b64_tr_b16 v[60:61], v8 offset:57344
  ds_read_b64_tr_b16 v[62:63], v8 offset:58112
  v_mfma_f32_32x32x16_bf16 v[72:87], v[36:39], v[24:27], v[72:87]
  ds_read_b64_tr_b16 v[64:65], v8 offset:57408
  ds_read_b64_tr_b16 v[66:67], v8 offset:58176
  v_mfma_f32_32x32x16_bf16 v[88:103], v[40:43], v[24:27], v[88:103]
  ds_read_b64_tr_b16 v[68:69], v8 offset:57472
  ds_read_b64_tr_b16 v[70:71], v8 offset:58240
  v_mfma_f32_32x32x16_bf16 v[104:119], v[44:47], v[24:27], v[104:119]
  ds_read_b128 v[24:27], v5 offset:57344
  ds_read_b64_tr_b16 v[36:37], v8 offset:60416
  ds_read_b64_tr_b16 v[38:39], v8 offset:61184
  v_mfma_f32_32x32x16_bf16 v[72:87], v[48:51], v[28:31], v[72:87]
  ds_read_b64_tr_b16 v[40:41], v8 offset:60480
  ds_read_b64_tr_b16 v[42:43], v8 offset:61248
  v_mfma_f32_32x32x16_bf16 v[88:103], v[52:55], v[28:31], v[88:103]
  ds_read_b64_tr_b16 v[44:45], v8 offset:60544
  ds_read_b64_tr_b16 v[46:47], v8 offset:61312
  v_mfma_f32_32x32x16_bf16 v[104:119], v[56:59], v[28:31], v[104:119]
  ds_read_b128 v[28:31], v6 offset:57344
  ds_read_b64_tr_b16 v[48:49], v8 offset:63488
  ds_read_b64_tr_b16 v[50:51], v8 offset:64256
  s_waitcnt lgkmcnt(14)
  v_mfma_f32_32x32x16_bf16 v[72:87], v[60:63], v[32:35], v[72:87]
  ds_read_b64_tr_b16 v[52:53], v8 offset:63552
  ds_read_b64_tr_b16 v[54:55], v8 offset:64320
  s_waitcnt lgkmcnt(14)
  v_mfma_f32_32x32x16_bf16 v[88:103], v[64:67], v[32:35], v[88:103]
  ds_read_b64_tr_b16 v[56:57], v8 offset:63616
  ds_read_b64_tr_b16 v[58:59], v8 offset:64384
  s_waitcnt lgkmcnt(14)
  v_mfma_f32_32x32x16_bf16 v[104:119], v[68:71], v[32:35], v[104:119]
  ds_read_b128 v[32:35], v7 offset:57344
  ds_read_b64_tr_b16 v[60:61], v15 offset:9216
  ds_read_b64_tr_b16 v[62:63], v15 offset:9984
  s_waitcnt lgkmcnt(14)
  v_mfma_f32_32x32x16_bf16 v[72:87], v[36:39], v[24:27], v[72:87]
  ds_read_b64_tr_b16 v[64:65], v15 offset:9280
  ds_read_b64_tr_b16 v[66:67], v15 offset:10048
  s_waitcnt lgkmcnt(14)
  v_mfma_f32_32x32x16_bf16 v[88:103], v[40:43], v[24:27], v[88:103]
  ds_read_b64_tr_b16 v[68:69], v15 offset:9344
  ds_read_b64_tr_b16 v[70:71], v15 offset:10112
  s_waitcnt lgkmcnt(14)
  v_mfma_f32_32x32x16_bf16 v[104:119], v[44:47], v[24:27], v[104:119]
  s_waitcnt lgkmcnt(0)
  s_barrier
  ds_read_b128 v[24:27], v4 offset:0
  ds_read_b64_tr_b16 v[36:37], v8 offset:0
  ds_read_b64_tr_b16 v[38:39], v8 offset:768
  v_mfma_f32_32x32x16_bf16 v[72:87], v[48:51], v[28:31], v[72:87]
  s_cmp_lg_u32 s37, 1
  s_cbranch_scc1 w2_6220_3006
  s_sub_u32 s51, s2, 172
  s_cmp_lt_u32 s2, 172
  s_cselect_b32 s44, s16, s8
  s_cselect_b32 s45, s17, s9
  s_cselect_b32 s50, s2, s51
  s_mov_b32 s46, 524288
  s_cselect_b32 s46, 1409024, s46
  s_mov_b32 s47, 131072
  s_lshl_b32 s50, s50, 13
  v_lshlrev_b32 v200, 7, v0
  buffer_load_dword v242, v200, s[44:47], s50 offen
w2_6220_3006:
  ds_read_b64_tr_b16 v[40:41], v8 offset:64
  ds_read_b64_tr_b16 v[42:43], v8 offset:832
  v_mfma_f32_32x32x16_bf16 v[88:103], v[52:55], v[28:31], v[88:103]
  ds_read_b64_tr_b16 v[44:45], v8 offset:128
  ds_read_b64_tr_b16 v[46:47], v8 offset:896
  v_mfma_f32_32x32x16_bf16 v[104:119], v[56:59], v[28:31], v[104:119]
  ds_read_b128 v[28:31], v5 offset:0
  ds_read_b64_tr_b16 v[48:49], v8 offset:3072
  ds_read_b64_tr_b16 v[50:51], v8 offset:3840
  v_mfma_f32_32x32x16_bf16 v[72:87], v[60:63], v[32:35], v[72:87]
  ds_read_b64_tr_b16 v[52:53], v8 offset:3136
  ds_read_b64_tr_b16 v[54:55], v8 offset:3904
  v_mfma_f32_32x32x16_bf16 v[88:103], v[64:67], v[32:35], v[88:103]
  ds_read_b64_tr_b16 v[56:57], v8 offset:3200
  ds_read_b64_tr_b16 v[58:59], v8 offset:3968
  v_mfma_f32_32x32x16_bf16 v[104:119], v[68:71], v[32:35], v[104:119]
  ds_read_b128 v[32:35], v6 offset:0
  ds_read_b64_tr_b16 v[60:61], v8 offset:6144
  ds_read_b64_tr_b16 v[62:63], v8 offset:6912
  s_waitcnt lgkmcnt(14)
  v_mfma_f32_32x32x16_bf16 v[72:87], v[36:39], v[24:27], v[72:87]
  buffer_load_dwordx4 v[204:207], v236, s[32:35], 0 offen sc1
  buffer_load_dwordx4 v[208:211], v237, s[32:35], 0 offen sc1
  buffer_load_dwordx4 v[212:215], v238, s[32:35], 0 offen sc1
  buffer_load_dwordx4 v[216:219], v239, s[32:35], 0 offen sc1
  buffer_load_dwordx4 v[220:223], v240, s[32:35], 0 offen sc1
  ds_read_b64_tr_b16 v[64:65], v8 offset:6208
  ds_read_b64_tr_b16 v[66:67], v8 offset:6976
  s_waitcnt lgkmcnt(14)
  v_mfma_f32_32x32x16_bf16 v[88:103], v[40:43], v[24:27], v[88:103]
  ds_read_b64_tr_b16 v[68:69], v8 offset:6272
  ds_read_b64_tr_b16 v[70:71], v8 offset:7040
  s_waitcnt lgkmcnt(14)
  v_mfma_f32_32x32x16_bf16 v[104:119], v[44:47], v[24:27], v[104:119]
  ds_read_b128 v[24:27], v7 offset:0
  ds_read_b64_tr_b16 v[36:37], v8 offset:9216
  ds_read_b64_tr_b16 v[38:39], v8 offset:9984
  s_waitcnt lgkmcnt(14)
  v_mfma_f32_32x32x16_bf16 v[72:87], v[48:51], v[28:31], v[72:87]
  ds_read_b64_tr_b16 v[40:41], v8 offset:9280
  ds_read_b64_tr_b16 v[42:43], v8 offset:10048
  s_waitcnt lgkmcnt(14)
  v_mfma_f32_32x32x16_bf16 v[88:103], v[52:55], v[28:31], v[88:103]
  ds_read_b64_tr_b16 v[44:45], v8 offset:9344
  ds_read_b64_tr_b16 v[46:47], v8 offset:10112
  s_waitcnt lgkmcnt(14)
  v_mfma_f32_32x32x16_bf16 v[104:119], v[56:59], v[28:31], v[104:119]
  s_waitcnt lgkmcnt(0)
  s_barrier
  ds_read_b128 v[28:31], v4 offset:28672
  ds_read_b64_tr_b16 v[48:49], v8 offset:28672
  ds_read_b64_tr_b16 v[50:51], v8 offset:29440
  v_mfma_f32_32x32x16_bf16 v[72:87], v[60:63], v[32:35], v[72:87]
  ds_read_b64_tr_b16 v[52:53], v8 offset:28736
  ds_read_b64_tr_b16 v[54:55], v8 offset:29504
  v_mfma_f32_32x32x16_bf16 v[88:103], v[64:67], v[32:35], v[88:103]
  ds_read_b64_tr_b16 v[56:57], v8 offset:28800
  ds_read_b64_tr_b16 v[58:59], v8 offset:29568
  v_mfma_f32_32x32x16_bf16 v[104:119], v[68:71], v[32:35], v[104:119]
  ds_read_b128 v[32:35], v5 offset:28672
  ds_read_b64_tr_b16 v[60:61], v8 offset:31744
  ds_read_b64_tr_b16 v[62:63], v8 offset:32512
  v_mfma_f32_32x32x16_bf16 v[72:87], v[36:39], v[24:27], v[72:87]
  ds_read_b64_tr_b16 v[64:65], v8 offset:31808
  ds_read_b64_tr_b16 v[66:67], v8 offset:32576
  v_mfma_f32_32x32x16_bf16 v[88:103], v[40:43], v[24:27], v[88:103]
  ds_read_b64_tr_b16 v[68:69], v8 offset:31872
  ds_read_b64_tr_b16 v[70:71], v8 offset:32640
  v_mfma_f32_32x32x16_bf16 v[104:119], v[44:47], v[24:27], v[104:119]
  ds_read_b128 v[24:27], v6 offset:28672
  ds_read_b64_tr_b16 v[36:37], v8 offset:34816
  ds_read_b64_tr_b16 v[38:39], v8 offset:35584
  s_waitcnt lgkmcnt(14)
  v_mfma_f32_32x32x16_bf16 v[72:87], v[48:51], v[28:31], v[72:87]
  ds_read_b64_tr_b16 v[40:41], v8 offset:34880
  ds_read_b64_tr_b16 v[42:43], v8 offset:35648
  s_waitcnt lgkmcnt(14)
  v_mfma_f32_32x32x16_bf16 v[88:103], v[52:55], v[28:31], v[88:103]
  ds_read_b64_tr_b16 v[44:45], v8 offset:34944
  ds_read_b64_tr_b16 v[46:47], v8 offset:35712
  s_waitcnt lgkmcnt(14)
  v_mfma_f32_32x32x16_bf16 v[104:119], v[56:59], v[28:31], v[104:119]
  ds_read_b128 v[28:31], v7 offset:28672
  ds_read_b64_tr_b16 v[48:49], v8 offset:37888
  ds_read_b64_tr_b16 v[50:51], v8 offset:38656
  s_waitcnt lgkmcnt(14)
  v_mfma_f32_32x32x16_bf16 v[72:87], v[60:63], v[32:35], v[72:87]
  ds_read_b64_tr_b16 v[52:53], v8 offset:37952
  ds_read_b64_tr_b16 v[54:55], v8 offset:38720
  s_waitcnt lgkmcnt(14)
  v_mfma_f32_32x32x16_bf16 v[88:103], v[64:67], v[32:35], v[88:103]
  s_waitcnt vmcnt(0)
gl_6220_3008:
  v_cmp_ne_u64 s[50:51], v[206:207], v[252:253]
  v_cmp_ne_u64 vcc, v[210:211], v[252:253]
  s_nop 0
  s_or_b64 s[50:51], s[50:51], vcc
  v_cmp_ne_u64 vcc, v[214:215], v[252:253]
  s_nop 0
  s_or_b64 s[50:51], s[50:51], vcc
  v_cmp_ne_u64 vcc, v[218:219], v[252:253]
  s_nop 0
  s_or_b64 s[50:51], s[50:51], vcc
  s_and_b64 s[50:51], s[50:51], s[64:65]
  v_cmp_ne_u64 vcc, v[222:223], v[252:253]
  s_nop 0
  s_or_b64 s[50:51], s[50:51], vcc
  s_cbranch_scc0 gok_6220_3007
  s_add_u32 s3, s3, 1
  s_cmp_gt_u32 s3, 4194304
  s_cbranch_scc1 gok_6220_3007
  s_sleep 4
  buffer_load_dwordx4 v[204:207], v236, s[32:35], 0 offen sc1
  buffer_load_dwordx4 v[208:211], v237, s[32:35], 0 offen sc1
  buffer_load_dwordx4 v[212:215], v238, s[32:35], 0 offen sc1
  buffer_load_dwordx4 v[216:219], v239, s[32:35], 0 offen sc1
  buffer_load_dwordx4 v[220:223], v240, s[32:35], 0 offen sc1
  s_waitcnt vmcnt(0)
  s_branch gl_6220_3008
gok_6220_3007:
  v_add_f32 v204, v204, v208
  v_add_f32 v212, v212, v216
  v_add_f32 v204, v204, v212
  v_add_f32 v205, v205, v209
  v_add_f32 v213, v213, v217
  v_add_f32 v205, v205, v213
  v_mov_b32 v10, v220
  v_mov_b32 v11, v221
  s_min_u32 s50, s37, 2
  s_lshl_b32 s50, s50, 9
  s_add_u32 s50, s50, 159744
  v_lshl_add_u32 v200, v0, 3, s50
  s_mov_b64 exec, s[64:65]
  ds_write_b64 v200, v[204:205] offset:0
  s_mov_b64 exec, -1
  s_lshl_b32 s50, s37, 8
  s_add_u32 s50, s50, 161280
  v_and_b32 v200, 31, v0
  v_lshl_add_u32 v200, v200, 3, s50
  ds_write_b64 v200, v[10:11] offset:0
  ds_read_b64_tr_b16 v[56:57], v8 offset:38016
  ds_read_b64_tr_b16 v[58:59], v8 offset:38784
  s_waitcnt lgkmcnt(15)
  v_mfma_f32_32x32x16_bf16 v[104:119], v[68:71], v[32:35], v[104:119]
  s_waitcnt lgkmcnt(0)
  s_barrier
  s_setprio 3
  v_mfma_f32_32x32x16_bf16 v[72:87], v[36:39], v[24:27], v[72:87]
  v_mfma_f32_32x32x16_bf16 v[88:103], v[40:43], v[24:27], v[88:103]
  v_mfma_f32_32x32x16_bf16 v[104:119], v[44:47], v[24:27], v[104:119]
  v_mfma_f32_32x32x16_bf16 v[72:87], v[48:51], v[28:31], v[72:87]
  v_mfma_f32_32x32x16_bf16 v[88:103], v[52:55], v[28:31], v[88:103]
  v_mfma_f32_32x32x16_bf16 v[104:119], v[56:59], v[28:31], v[104:119]
  s_setprio 3
  ds_read_b128 v[136:139], v12 offset:0
  ds_read_b128 v[140:143], v12 offset:32
  s_mul_i32 s49, s40, 3
  s_lshl_b32 s42, s39, 2
  s_add_u32 s42, s42, s37
  s_lshl_b32 s97, s42, 10
  s_add_u32 s42, s49, 0
  s_cmp_lt_u32 s42, 16
  s_cselect_b32 s43, 0x3eb8aa3b, 1.0
  v_mul_f32 v1, s43, v11
  s_lshl_b32 s50, s42, 17
  s_add_u32 s50, s50, s97
  s_add_u32 s51, s50, 65536
  ds_read_b128 v[144:147], v12 offset:64
  ds_read_b128 v[148:151], v12 offset:96
  s_waitcnt lgkmcnt(2)
  v_fmac_f32 v72, v10, v136
  v_fmac_f32 v73, v10, v137
  v_fmac_f32 v74, v10, v138
  v_fmac_f32 v75, v10, v139
  v_fmac_f32 v76, v10, v140
  v_fmac_f32 v77, v10, v141
  v_fmac_f32 v78, v10, v142
  v_fmac_f32 v79, v10, v143
  v_mul_f32 v72, v1, v72
  v_mul_f32 v73, v1, v73
  v_mul_f32 v74, v1, v74
  v_mul_f32 v75, v1, v75
  v_mul_f32 v76, v1, v76
  v_mul_f32 v77, v1, v77
  v_mul_f32 v78, v1, v78
  v_mul_f32 v79, v1, v79
  v_cvt_pk_bf16_f32 v72, v72, v73
  v_cvt_pk_bf16_f32 v73, v74, v75
  v_cvt_pk_bf16_f32 v74, v76, v77
  v_cvt_pk_bf16_f32 v75, v78, v79
  ds_read_b128 v[136:139], v12 offset:128
  ds_read_b128 v[140:143], v12 offset:160
  s_waitcnt lgkmcnt(2)
  v_fmac_f32 v80, v10, v144
  v_fmac_f32 v81, v10, v145
  v_fmac_f32 v82, v10, v146
  v_fmac_f32 v83, v10, v147
  v_fmac_f32 v84, v10, v148
  v_fmac_f32 v85, v10, v149
  v_fmac_f32 v86, v10, v150
  v_fmac_f32 v87, v10, v151
  v_mul_f32 v80, v1, v80
  v_mul_f32 v81, v1, v81
  v_mul_f32 v82, v1, v82
  v_mul_f32 v83, v1, v83
  v_mul_f32 v84, v1, v84
  v_mul_f32 v85, v1, v85
  v_mul_f32 v86, v1, v86
  v_mul_f32 v87, v1, v87
  v_cvt_pk_bf16_f32 v80, v80, v81
  v_cvt_pk_bf16_f32 v81, v82, v83
  v_cvt_pk_bf16_f32 v82, v84, v85
  v_cvt_pk_bf16_f32 v83, v86, v87
  s_cmp_ge_u32 s42, 32
  s_cbranch_scc1 ev_6220_3009
  buffer_store_dwordx4 v[72:75], v13, s[32:35], s50 offen sc1
  buffer_store_dwordx4 v[80:83], v13, s[32:35], s51 offen sc1
  s_branch ej_6220_3010
ev_6220_3009:
  v_mfma_f32_32x32x16_bf16 v[120:135], v[72:75], v[16:19], 0
  v_mfma_f32_32x32x16_bf16 v[120:135], v[80:83], v[20:23], v[120:135]
  s_nop 13
  v_cvt_pk_bf16_f32 v72, v120, v121
  v_cvt_pk_bf16_f32 v73, v122, v123
  v_cvt_pk_bf16_f32 v74, v124, v125
  v_cvt_pk_bf16_f32 v75, v126, v127
  v_cvt_pk_bf16_f32 v76, v128, v129
  v_cvt_pk_bf16_f32 v77, v130, v131
  v_cvt_pk_bf16_f32 v78, v132, v133
  v_cvt_pk_bf16_f32 v79, v134, v135
  buffer_store_dwordx4 v[72:75], v14, s[32:35], s50 offen sc1
  buffer_store_dwordx4 v[76:79], v14, s[32:35], s50 offen offset:512 sc1
ej_6220_3010:
  s_add_u32 s42, s49, 1
  s_cmp_lt_u32 s42, 16
  s_cselect_b32 s43, 0x3eb8aa3b, 1.0
  v_mul_f32 v1, s43, v11
  s_lshl_b32 s50, s42, 17
  s_add_u32 s50, s50, s97
  s_add_u32 s51, s50, 65536
  ds_read_b128 v[144:147], v12 offset:192
  ds_read_b128 v[148:151], v12 offset:224
  s_waitcnt lgkmcnt(2)
  v_fmac_f32 v88, v10, v136
  v_fmac_f32 v89, v10, v137
  v_fmac_f32 v90, v10, v138
  v_fmac_f32 v91, v10, v139
  v_fmac_f32 v92, v10, v140
  v_fmac_f32 v93, v10, v141
  v_fmac_f32 v94, v10, v142
  v_fmac_f32 v95, v10, v143
  v_mul_f32 v88, v1, v88
  v_mul_f32 v89, v1, v89
  v_mul_f32 v90, v1, v90
  v_mul_f32 v91, v1, v91
  v_mul_f32 v92, v1, v92
  v_mul_f32 v93, v1, v93
  v_mul_f32 v94, v1, v94
  v_mul_f32 v95, v1, v95
  v_cvt_pk_bf16_f32 v88, v88, v89
  v_cvt_pk_bf16_f32 v89, v90, v91
  v_cvt_pk_bf16_f32 v90, v92, v93
  v_cvt_pk_bf16_f32 v91, v94, v95
  ds_read_b128 v[136:139], v12 offset:256
  ds_read_b128 v[140:143], v12 offset:288
  s_waitcnt lgkmcnt(2)
  v_fmac_f32 v96, v10, v144
  v_fmac_f32 v97, v10, v145
  v_fmac_f32 v98, v10, v146
  v_fmac_f32 v99, v10, v147
  v_fmac_f32 v100, v10, v148
  v_fmac_f32 v101, v10, v149
  v_fmac_f32 v102, v10, v150
  v_fmac_f32 v103, v10, v151
  v_mul_f32 v96, v1, v96
  v_mul_f32 v97, v1, v97
  v_mul_f32 v98, v1, v98
  v_mul_f32 v99, v1, v99
  v_mul_f32 v100, v1, v100
  v_mul_f32 v101, v1, v101
  v_mul_f32 v102, v1, v102
  v_mul_f32 v103, v1, v103
  v_cvt_pk_bf16_f32 v96, v96, v97
  v_cvt_pk_bf16_f32 v97, v98, v99
  v_cvt_pk_bf16_f32 v98, v100, v101
  v_cvt_pk_bf16_f32 v99, v102, v103
  s_cmp_ge_u32 s42, 32
  s_cbranch_scc1 ev_6220_3011
  buffer_store_dwordx4 v[88:91], v13, s[32:35], s50 offen sc1
  buffer_store_dwordx4 v[96:99], v13, s[32:35], s51 offen sc1
  s_branch ej_6220_3012
ev_6220_3011:
  v_mfma_f32_32x32x16_bf16 v[120:135], v[88:91], v[16:19], 0
  v_mfma_f32_32x32x16_bf16 v[120:135], v[96:99], v[20:23], v[120:135]
  s_nop 13
  v_cvt_pk_bf16_f32 v88, v120, v121
  v_cvt_pk_bf16_f32 v89, v122, v123
  v_cvt_pk_bf16_f32 v90, v124, v125
  v_cvt_pk_bf16_f32 v91, v126, v127
  v_cvt_pk_bf16_f32 v92, v128, v129
  v_cvt_pk_bf16_f32 v93, v130, v131
  v_cvt_pk_bf16_f32 v94, v132, v133
  v_cvt_pk_bf16_f32 v95, v134, v135
  buffer_store_dwordx4 v[88:91], v14, s[32:35], s50 offen sc1
  buffer_store_dwordx4 v[92:95], v14, s[32:35], s50 offen offset:512 sc1
ej_6220_3012:
  s_add_u32 s42, s49, 2
  s_cmp_lt_u32 s42, 16
  s_cselect_b32 s43, 0x3eb8aa3b, 1.0
  v_mul_f32 v1, s43, v11
  s_lshl_b32 s50, s42, 17
  s_add_u32 s50, s50, s97
  s_add_u32 s51, s50, 65536
  ds_read_b128 v[144:147], v12 offset:320
  ds_read_b128 v[148:151], v12 offset:352
  s_waitcnt lgkmcnt(2)
  v_fmac_f32 v104, v10, v136
  v_fmac_f32 v105, v10, v137
  v_fmac_f32 v106, v10, v138
  v_fmac_f32 v107, v10, v139
  v_fmac_f32 v108, v10, v140
  v_fmac_f32 v109, v10, v141
  v_fmac_f32 v110, v10, v142
  v_fmac_f32 v111, v10, v143
  v_mul_f32 v104, v1, v104
  v_mul_f32 v105, v1, v105
  v_mul_f32 v106, v1, v106
  v_mul_f32 v107, v1, v107
  v_mul_f32 v108, v1, v108
  v_mul_f32 v109, v1, v109
  v_mul_f32 v110, v1, v110
  v_mul_f32 v111, v1, v111
  v_cvt_pk_bf16_f32 v104, v104, v105
  v_cvt_pk_bf16_f32 v105, v106, v107
  v_cvt_pk_bf16_f32 v106, v108, v109
  v_cvt_pk_bf16_f32 v107, v110, v111
  s_waitcnt lgkmcnt(0)
  v_fmac_f32 v112, v10, v144
  v_fmac_f32 v113, v10, v145
  v_fmac_f32 v114, v10, v146
  v_fmac_f32 v115, v10, v147
  v_fmac_f32 v116, v10, v148
  v_fmac_f32 v117, v10, v149
  v_fmac_f32 v118, v10, v150
  v_fmac_f32 v119, v10, v151
  v_mul_f32 v112, v1, v112
  v_mul_f32 v113, v1, v113
  v_mul_f32 v114, v1, v114
  v_mul_f32 v115, v1, v115
  v_mul_f32 v116, v1, v116
  v_mul_f32 v117, v1, v117
  v_mul_f32 v118, v1, v118
  v_mul_f32 v119, v1, v119
  v_cvt_pk_bf16_f32 v112, v112, v113
  v_cvt_pk_bf16_f32 v113, v114, v115
  v_cvt_pk_bf16_f32 v114, v116, v117
  v_cvt_pk_bf16_f32 v115, v118, v119
  s_cmp_ge_u32 s42, 32
  s_cbranch_scc1 ev_6220_3013
  buffer_store_dwordx4 v[104:107], v13, s[32:35], s50 offen sc1
  buffer_store_dwordx4 v[112:115], v13, s[32:35], s51 offen sc1
  s_branch ej_6220_3014
ev_6220_3013:
  v_mfma_f32_32x32x16_bf16 v[120:135], v[104:107], v[16:19], 0
  v_mfma_f32_32x32x16_bf16 v[120:135], v[112:115], v[20:23], v[120:135]
  s_nop 13
  v_cvt_pk_bf16_f32 v104, v120, v121
  v_cvt_pk_bf16_f32 v105, v122, v123
  v_cvt_pk_bf16_f32 v106, v124, v125
  v_cvt_pk_bf16_f32 v107, v126, v127
  v_cvt_pk_bf16_f32 v108, v128, v129
  v_cvt_pk_bf16_f32 v109, v130, v131
  v_cvt_pk_bf16_f32 v110, v132, v133
  v_cvt_pk_bf16_f32 v111, v134, v135
  buffer_store_dwordx4 v[104:107], v14, s[32:35], s50 offen sc1
  buffer_store_dwordx4 v[108:111], v14, s[32:35], s50 offen offset:512 sc1
ej_6220_3014:
  s_lshl_b32 s49, s39, 4
  s_add_u32 s49, s49, s40
  s_lshl_b32 s49, s49, 7
  s_add_u32 s49, s49, 14680064
  s_waitcnt vmcnt(0)
  v_mov_b32 v1, 163760
  v_mov_b32 v2, 1
  s_mov_b64 exec, 1
  ds_add_rtn_u32 v3, v1, v2
  s_waitcnt lgkmcnt(0)
  v_readfirstlane_b32 s48, v3
  s_nop 0
  s_cmp_lg_u32 s48, 3
  s_cbranch_scc1 nf_6220_3015
  buffer_store_dwordx2 v[252:253], v254, s[32:35], s49 offen sc1
nf_6220_3015:
  s_mov_b64 exec, -1
  s_setprio 1
  s_add_u32 m0, s62, 24704
  s_mov_b32 s41, 704512
  buffer_load_dwordx4 v244, s[52:55], s41 offen lds
  buffer_load_dwordx4 v245, s[52:55], s41 offen offset:1024 lds
  buffer_load_dwordx4 v246, s[52:55], s41 offen offset:2048 lds
  buffer_load_dwordx4 v247, s[52:55], s41 offen offset:3072 lds
  s_add_u32 m0, s62, 28800
  s_nop 0
  buffer_load_dwordx4 v248, s[52:55], s41 offen lds
  buffer_load_dwordx4 v249, s[52:55], s41 offen offset:1024 lds
  s_and_b32 s42, s2, 7
  s_lshl_b32 s47, s42, 2
  s_add_u32 s47, s47, s37
  s_lshr_b32 s46, s2, 3
  v_and_b32 v3, 3, v0
  v_min_u32 v3, 2, v3
  v_bfe_u32 v4, v0, 2, 1
  v_lshl_add_u32 v3, v3, 4, v4
  s_lshl_b32 s42, s42, 1
  v_add_u32 v3, s42, v3
  v_mul_u32_u24 v3, 21846, v3
  v_lshrrev_b32 v3, 16, v3
  v_bfe_u32 v4, v0, 3, 2
  v_min_u32 v4, 2, v4
  s_lshr_b32 s43, s46, 1
  v_sub_u32 v4, s43, v4
  v_max_i32 v4, 0, v4
  v_lshl_add_u32 v3, v4, 4, v3
  v_lshlrev_b32 v3, 7, v3
  v_add_u32 v148, 14680064, v3
  s_lshl_b32 s96, s47, 16
  s_lshl_b32 s43, s46, 11
  s_add_u32 s96, s96, s43
  v_lshlrev_b32 v1, 4, v0
  s_lshl_b32 s43, s47, 16
  s_add_i32 s42, s96, -8192
  s_max_i32 s42, s42, s43
  s_add_u32 s24, s42, 2097152
  s_add_u32 s10, s42, 4194304
  s_add_i32 s42, s96, -6144
  s_max_i32 s42, s42, s43
  s_add_u32 s25, s42, 2097152
  s_add_u32 s11, s42, 4194304
  s_add_i32 s42, s96, -4096
  s_max_i32 s42, s42, s43
  s_add_u32 s26, s42, 2097152
  s_add_u32 s12, s42, 4194304
  s_add_i32 s42, s96, -2048
  s_max_i32 s42, s42, s43
  s_add_u32 s27, s42, 2097152
  s_add_u32 s13, s42, 4194304
  s_add_i32 s42, s96, 0
  s_max_i32 s42, s42, s43
  s_add_u32 s28, s42, 2097152
  s_add_u32 s14, s42, 4194304
  v_and_b32 v3, 15, v0
  v_lshlrev_b32 v3, 4, v3
  v_lshrrev_b32 v4, 5, v0
  v_lshl_add_u32 v2, v4, 8, v3
  s_mov_b32 s44, 0xffff
  s_mov_b32 s45, 0xffff
  s_add_u32 m0, s62, 49408
  s_mov_b32 s41, 880640
  buffer_load_dwordx4 v244, s[52:55], s41 offen lds
  buffer_load_dwordx4 v245, s[52:55], s41 offen offset:1024 lds
  buffer_load_dwordx4 v246, s[52:55], s41 offen offset:2048 lds
  buffer_load_dwordx4 v247, s[52:55], s41 offen offset:3072 lds
  s_add_u32 m0, s62, 53504
  s_nop 0
  buffer_load_dwordx4 v248, s[52:55], s41 offen lds
  buffer_load_dwordx4 v249, s[52:55], s41 offen offset:1024 lds
  v_and_b32 v3, 31, v0
  v_lshlrev_b32 v4, 2, v4
  v_sub_u32 v3, v3, v4
  v_cmp_le_i32 s[64:65], 0, v3
  v_cmp_le_i32 s[66:67], 1, v3
  v_cmp_le_i32 s[68:69], 2, v3
  v_cmp_le_i32 s[70:71], 3, v3
  v_cmp_le_i32 s[72:73], 8, v3
  v_cmp_le_i32 s[74:75], 9, v3
  v_cmp_le_i32 s[76:77], 10, v3
  v_cmp_le_i32 s[78:79], 11, v3
  v_cmp_le_i32 s[80:81], 16, v3
  v_cmp_le_i32 s[82:83], 17, v3
  v_cmp_le_i32 s[84:85], 18, v3
  v_cmp_le_i32 s[86:87], 19, v3
  v_cmp_le_i32 s[88:89], 24, v3
  v_cmp_le_i32 s[90:91], 25, v3
  v_cmp_le_i32 s[92:93], 26, v3
  v_cmp_le_i32 s[94:95], 27, v3
  v_mov_b32 v7, 0xf149f2ca
  v_mov_b32 v3, 0xffff
  v_mov_b32 v4, 0xffff0000
  v_cndmask_b32 v12, 0, v3, s[64:65]
  v_cndmask_b32 v5, 0, v4, s[66:67]
  v_or_b32 v12, v12, v5
  v_cndmask_b32 v13, 0, v3, s[68:69]
  v_cndmask_b32 v5, 0, v4, s[70:71]
  v_or_b32 v13, v13, v5
  v_cndmask_b32 v14, 0, v3, s[72:73]
  v_cndmask_b32 v5, 0, v4, s[74:75]
  v_or_b32 v14, v14, v5
  v_cndmask_b32 v15, 0, v3, s[76:77]
  v_cndmask_b32 v5, 0, v4, s[78:79]
  v_or_b32 v15, v15, v5
  v_cndmask_b32 v16, 0, v3, s[80:81]
  v_cndmask_b32 v5, 0, v4, s[82:83]
  v_or_b32 v16, v16, v5
  v_cndmask_b32 v17, 0, v3, s[84:85]
  v_cndmask_b32 v5, 0, v4, s[86:87]
  v_or_b32 v17, v17, v5
  v_cndmask_b32 v18, 0, v3, s[88:89]
  v_cndmask_b32 v5, 0, v4, s[90:91]
  v_or_b32 v18, v18, v5
  v_cndmask_b32 v19, 0, v3, s[92:93]
  v_cndmask_b32 v5, 0, v4, s[94:95]
  v_or_b32 v19, v19, v5
  s_waitcnt vmcnt(6)
  s_lshl_b32 s48, s37, 2
  s_add_u32 s48, s48, 163712
  v_mov_b32 v3, s48
  v_mov_b32 v4, 12
  ds_write_b32 v3, v4 offset:0
  v_mov_b32 v10, 0x3f803f80
  v_mov_b32 v11, 0x3f803f80
  v_mov_b32 v68, v10
  v_mov_b32 v69, v10
  v_mov_b32 v70, v10
  v_mov_b32 v71, v10
  v_mov_b32 v72, v10
  v_mov_b32 v73, v10
  v_mov_b32 v74, v10
  v_mov_b32 v75, v10
  v_mov_b32 v76, v10
  v_mov_b32 v77, v10
  v_mov_b32 v78, v10
  v_mov_b32 v79, v10
  v_mov_b32 v80, v10
  v_mov_b32 v81, v10
  v_mov_b32 v82, v10
  v_mov_b32 v83, v10
  v_mov_b32 v84, v10
  v_mov_b32 v85, v10
  v_mov_b32 v86, v10
  v_mov_b32 v87, v10
  v_mov_b32 v88, v10
  v_mov_b32 v89, v10
  v_mov_b32 v90, v10
  v_mov_b32 v91, v10
  v_mov_b32 v92, v10
  v_mov_b32 v93, v10
  v_mov_b32 v94, v10
  v_mov_b32 v95, v10
  v_mov_b32 v96, v10
  v_mov_b32 v97, v10
  v_mov_b32 v98, v10
  v_mov_b32 v99, v10
  v_mov_b32 v100, v10
  v_mov_b32 v101, v10
  v_mov_b32 v102, v10
  v_mov_b32 v103, v10
  v_mov_b32 v104, v10
  v_mov_b32 v105, v10
  v_mov_b32 v106, v10
  v_mov_b32 v107, v10
  v_mov_b32 v108, v10
  v_mov_b32 v109, v10
  v_mov_b32 v110, v10
  v_mov_b32 v111, v10
  v_mov_b32 v112, v10
  v_mov_b32 v113, v10
  v_mov_b32 v114, v10
  v_mov_b32 v115, v10
  v_mov_b32 v116, v10
  v_mov_b32 v117, v10
  v_mov_b32 v118, v10
  v_mov_b32 v119, v10
  v_mov_b32 v120, v10
  v_mov_b32 v121, v10
  v_mov_b32 v122, v10
  v_mov_b32 v123, v10
  v_mov_b32 v124, v10
  v_mov_b32 v125, v10
  v_mov_b32 v126, v10
  v_mov_b32 v127, v10
  v_mov_b32 v128, v10
  v_mov_b32 v129, v10
  v_mov_b32 v130, v10
  v_mov_b32 v131, v10
  v_mov_b32 v132, v10
  v_mov_b32 v133, v10
  v_mov_b32 v134, v10
  v_mov_b32 v135, v10
  v_mov_b32 v136, v10
  v_mov_b32 v137, v10
  v_mov_b32 v138, v10
  v_mov_b32 v139, v10
  v_mov_b32 v140, v10
  v_mov_b32 v141, v10
  v_mov_b32 v142, v10
  v_mov_b32 v143, v10
  v_mov_b32 v144, v10
  v_mov_b32 v145, v10
  v_mov_b32 v146, v10
  v_mov_b32 v147, v10
  s_lshl_b32 s43, s46, 16
  s_lshl_b32 s60, s47, 11
  s_add_u32 s60, s60, s43
  s_add_u32 s60, s60, 12582912
  ds_read_b128 v[228:231], v9 offset:16
  s_waitcnt lgkmcnt(0)
lsp_6220_3016:
  v_min3_u32 v228, v228, v229, v230
  v_min_u32 v228, v228, v231
  v_cmp_gt_u32 vcc, 8, v228
  s_nop 4
  s_cbranch_vccz lok_6220_3017
  s_add_u32 s3, s3, 1
  s_cmp_gt_u32 s3, 4194304
  s_cbranch_scc1 lok_6220_3017
  ds_read_b128 v[228:231], v9 offset:16
  s_waitcnt lgkmcnt(0)
  s_branch lsp_6220_3016
lok_6220_3017:
  s_add_u32 m0, s62, 98816
  s_mov_b32 s41, 1056768
  buffer_load_dwordx4 v244, s[52:55], s41 offen lds
  buffer_load_dwordx4 v245, s[52:55], s41 offen offset:1024 lds
  buffer_load_dwordx4 v246, s[52:55], s41 offen offset:2048 lds
  buffer_load_dwordx4 v247, s[52:55], s41 offen offset:3072 lds
  s_add_u32 m0, s62, 102912
  s_nop 0
  buffer_load_dwordx4 v248, s[52:55], s41 offen lds
  buffer_load_dwordx4 v249, s[52:55], s41 offen offset:1024 lds
  s_waitcnt vmcnt(6)
  s_lshl_b32 s48, s37, 2
  s_add_u32 s48, s48, 163712
  v_mov_b32 v3, s48
  v_mov_b32 v4, 13
  ds_write_b32 v3, v4 offset:0
  ds_read_b128 v[228:231], v9 offset:16
  s_waitcnt lgkmcnt(0)
lsp_6220_3018:
  v_min3_u32 v228, v228, v229, v230
  v_min_u32 v228, v228, v231
  v_cmp_gt_u32 vcc, 9, v228
  s_nop 4
  s_cbranch_vccz lok_6220_3019
  s_add_u32 s3, s3, 1
  s_cmp_gt_u32 s3, 4194304
  s_cbranch_scc1 lok_6220_3019
  ds_read_b128 v[228:231], v9 offset:16
  s_waitcnt lgkmcnt(0)
  s_branch lsp_6220_3018
lok_6220_3019:
  s_add_u32 m0, s62, 123520
  s_mov_b32 s41, 1232896
  buffer_load_dwordx4 v244, s[52:55], s41 offen lds
  buffer_load_dwordx4 v245, s[52:55], s41 offen offset:1024 lds
  buffer_load_dwordx4 v246, s[52:55], s41 offen offset:2048 lds
  buffer_load_dwordx4 v247, s[52:55], s41 offen offset:3072 lds
  s_add_u32 m0, s62, 127616
  s_nop 0
  buffer_load_dwordx4 v248, s[52:55], s41 offen lds
  buffer_load_dwordx4 v249, s[52:55], s41 offen offset:1024 lds
  s_waitcnt vmcnt(6)
  s_lshl_b32 s48, s37, 2
  s_add_u32 s48, s48, 163712
  v_mov_b32 v3, s48
  v_mov_b32 v4, 14
  ds_write_b32 v3, v4 offset:0
  buffer_load_dwordx2 v[150:151], v148, s[32:35], 0 offen sc1
  s_lshr_b32 s50, s2, 3
  s_sub_u32 s51, s50, 22
  s_cmp_lt_u32 s50, 22
  s_cselect_b32 s56, s16, s8
  s_cselect_b32 s57, s17, s9
  s_cselect_b32 s50, s50, s51
  s_mov_b32 s58, 524288
  s_cselect_b32 s58, 1409024, s58
  s_mov_b32 s59, 131072
  s_lshl_b32 s50, s50, 16
  s_lshl_b32 s51, s37, 14
  s_add_u32 s50, s50, s51
  s_and_b32 s51, s2, 1
  s_lshl_b32 s51, s51, 9
  s_add_u32 s50, s50, s51
  v_lshrrev_b32 v232, 2, v0
  v_lshlrev_b32 v232, 10, v232
  v_and_b32 v233, 3, v0
  v_lshl_add_u32 v232, v233, 7, v232
  buffer_load_dword v233, v232, s[56:59], s50 offen
  s_waitcnt vmcnt(2)
  s_lshl_b32 s48, s37, 2
  s_add_u32 s48, s48, 163712
  v_mov_b32 v3, s48
  v_mov_b32 v4, 15
  ds_write_b32 v3, v4 offset:0
  s_waitcnt vmcnt(1)
poll_6220_3020:
  v_cmp_ne_u64 vcc, v[150:151], v[252:253]
  s_nop 4
  s_cbranch_vccz pok_6220_3021
  s_add_u32 s3, s3, 1
  s_cmp_gt_u32 s3, 4194304
  s_cbranch_scc1 pok_6220_3021
  s_sleep 8
  buffer_load_dwordx2 v[150:151], v148, s[32:35], 0 offen sc1
  s_waitcnt vmcnt(0)
  s_branch poll_6220_3020
pok_6220_3021:
  buffer_load_dwordx4 v[20:23], v1, s[32:35], s96 offen sc1
  buffer_load_dwordx4 v[28:31], v1, s[32:35], s24 offen sc1
  buffer_load_dwordx4 v[60:63], v1, s[32:35], s28 offen sc1
  buffer_load_dwordx4 v[56:59], v1, s[32:35], s27 offen offset:1024 sc1
  buffer_load_dwordx4 v[52:55], v1, s[32:35], s27 offen sc1
  buffer_load_dwordx4 v[48:51], v1, s[32:35], s26 offen offset:1024 sc1
  buffer_load_dwordx4 v[44:47], v1, s[32:35], s26 offen sc1
  buffer_load_dwordx4 v[40:43], v1, s[32:35], s25 offen offset:1024 sc1
  buffer_load_dwordx4 v[36:39], v1, s[32:35], s25 offen sc1
  buffer_load_dwordx4 v[32:35], v1, s[32:35], s24 offen offset:1024 sc1
  s_mov_b64 exec, s[44:45]
  buffer_load_dwordx4 v[132:135], v2, s[32:35], s14 offen sc1
  buffer_load_dwordx4 v[136:139], v2, s[32:35], s14 offen offset:512 sc1
  buffer_load_dwordx4 v[68:71], v2, s[32:35], s10 offen sc1
  buffer_load_dwordx4 v[72:75], v2, s[32:35], s10 offen offset:512 sc1
  buffer_load_dwordx4 v[124:127], v2, s[32:35], s13 offen offset:1024 sc1
  buffer_load_dwordx4 v[128:131], v2, s[32:35], s13 offen offset:1536 sc1
  buffer_load_dwordx4 v[116:119], v2, s[32:35], s13 offen sc1
  buffer_load_dwordx4 v[120:123], v2, s[32:35], s13 offen offset:512 sc1
  buffer_load_dwordx4 v[108:111], v2, s[32:35], s12 offen offset:1024 sc1
  buffer_load_dwordx4 v[112:115], v2, s[32:35], s12 offen offset:1536 sc1
  buffer_load_dwordx4 v[100:103], v2, s[32:35], s12 offen sc1
  buffer_load_dwordx4 v[104:107], v2, s[32:35], s12 offen offset:512 sc1
  buffer_load_dwordx4 v[92:95], v2, s[32:35], s11 offen offset:1024 sc1
  buffer_load_dwordx4 v[96:99], v2, s[32:35], s11 offen offset:1536 sc1
  buffer_load_dwordx4 v[84:87], v2, s[32:35], s11 offen sc1
  buffer_load_dwordx4 v[88:91], v2, s[32:35], s11 offen offset:512 sc1
  buffer_load_dwordx4 v[76:79], v2, s[32:35], s10 offen offset:1024 sc1
  buffer_load_dwordx4 v[80:83], v2, s[32:35], s10 offen offset:1536 sc1
  buffer_load_dwordx4 v[140:143], v2, s[32:35], s14 offen offset:1024 sc1
  buffer_load_dwordx4 v[144:147], v2, s[32:35], s14 offen offset:1536 sc1
  s_mov_b64 exec, -1
  buffer_load_dwordx4 v[24:27], v1, s[32:35], s96 offen offset:1024 sc1
  buffer_load_dwordx4 v[64:67], v1, s[32:35], s28 offen offset:1024 sc1
  s_lshl_b32 s43, s46, 1
  s_add_u32 s43, s43, 0
  s_min_u32 s61, s43, 7
  s_waitcnt vmcnt(30)
  v_mfma_f32_32x32x16_bf16 v[148:163], v[28:31], v[20:23], 0
  s_waitcnt vmcnt(29)
  v_mfma_f32_32x32x16_bf16 v[164:179], v[60:63], v[20:23], 0
  s_waitcnt vmcnt(28)
  v_mfma_f32_32x32x16_bf16 v[180:195], v[56:59], v[20:23], 0
  s_waitcnt vmcnt(27)
  v_mfma_f32_32x32x16_bf16 v[196:211], v[52:55], v[20:23], 0
  s_nop 7
  s_cmp_lt_u32 s43, 8
  s_cbranch_scc1 m1_6220_3024
  v_cndmask_b32 v212, v148, v164, s[64:65]
  v_cndmask_b32 v213, v149, v165, s[66:67]
  v_cndmask_b32 v214, v150, v166, s[68:69]
  v_cndmask_b32 v215, v151, v167, s[70:71]
  v_cndmask_b32 v216, v152, v168, s[72:73]
  v_cndmask_b32 v217, v153, v169, s[74:75]
  v_cndmask_b32 v218, v154, v170, s[76:77]
  v_cndmask_b32 v219, v155, v171, s[78:79]
  v_cndmask_b32 v220, v156, v172, s[80:81]
  v_cndmask_b32 v221, v157, v173, s[82:83]
  v_cndmask_b32 v222, v158, v174, s[84:85]
  v_cndmask_b32 v223, v159, v175, s[86:87]
  v_cndmask_b32 v224, v160, v176, s[88:89]
  v_cndmask_b32 v225, v161, v177, s[90:91]
  v_cndmask_b32 v226, v162, v178, s[92:93]
  v_cndmask_b32 v227, v163, v179, s[94:95]
m2_6220_3025:
  v_max_f32 v5, v212, v213
  v_max_f32 v6, v214, v215
  v_max3_f32 v5, v216, v217, v5
  v_max3_f32 v6, v218, v219, v6
  v_max3_f32 v5, v220, v221, v5
  v_max3_f32 v6, v222, v223, v6
  v_max3_f32 v5, v224, v225, v5
  v_max3_f32 v6, v226, v227, v6
  s_cmp_lt_u32 s61, 1
  s_cbranch_scc1 p1_6220_3022
  s_waitcnt vmcnt(26)
  v_mfma_f32_32x32x16_bf16 v[148:163], v[48:51], v[20:23], 0
  v_max3_f32 v5, v180, v181, v5
  v_max3_f32 v6, v182, v183, v6
  v_max3_f32 v5, v184, v185, v5
  v_max3_f32 v6, v186, v187, v6
  v_max3_f32 v5, v188, v189, v5
  v_max3_f32 v6, v190, v191, v6
  v_max3_f32 v5, v192, v193, v5
  v_max3_f32 v6, v194, v195, v6
  s_cmp_lt_u32 s61, 2
  s_cbranch_scc1 p1_6220_3022
  s_waitcnt vmcnt(25)
  v_mfma_f32_32x32x16_bf16 v[164:179], v[44:47], v[20:23], 0
  v_max3_f32 v5, v196, v197, v5
  v_max3_f32 v6, v198, v199, v6
  v_max3_f32 v5, v200, v201, v5
  v_max3_f32 v6, v202, v203, v6
  v_max3_f32 v5, v204, v205, v5
  v_max3_f32 v6, v206, v207, v6
  v_max3_f32 v5, v208, v209, v5
  v_max3_f32 v6, v210, v211, v6
  s_cmp_lt_u32 s61, 3
  s_cbranch_scc1 p1_6220_3022
  s_waitcnt vmcnt(24)
  v_mfma_f32_32x32x16_bf16 v[180:195], v[40:43], v[20:23], 0
  v_max3_f32 v5, v148, v149, v5
  v_max3_f32 v6, v150, v151, v6
  v_max3_f32 v5, v152, v153, v5
  v_max3_f32 v6, v154, v155, v6
  v_max3_f32 v5, v156, v157, v5
  v_max3_f32 v6, v158, v159, v6
  v_max3_f32 v5, v160, v161, v5
  v_max3_f32 v6, v162, v163, v6
  s_cmp_lt_u32 s61, 4
  s_cbranch_scc1 p1_6220_3022
  s_waitcnt vmcnt(23)
  v_mfma_f32_32x32x16_bf16 v[196:211], v[36:39], v[20:23], 0
  v_max3_f32 v5, v164, v165, v5
  v_max3_f32 v6, v166, v167, v6
  v_max3_f32 v5, v168, v169, v5
  v_max3_f32 v6, v170, v171, v6
  v_max3_f32 v5, v172, v173, v5
  v_max3_f32 v6, v174, v175, v6
  v_max3_f32 v5, v176, v177, v5
  v_max3_f32 v6, v178, v179, v6
  s_cmp_lt_u32 s61, 5
  s_cbranch_scc1 p1_6220_3022
  s_waitcnt vmcnt(22)
  v_mfma_f32_32x32x16_bf16 v[148:163], v[32:35], v[20:23], 0
  v_max3_f32 v5, v180, v181, v5
  v_max3_f32 v6, v182, v183, v6
  v_max3_f32 v5, v184, v185, v5
  v_max3_f32 v6, v186, v187, v6
  v_max3_f32 v5, v188, v189, v5
  v_max3_f32 v6, v190, v191, v6
  v_max3_f32 v5, v192, v193, v5
  v_max3_f32 v6, v194, v195, v6
  s_cmp_lt_u32 s61, 6
  s_cbranch_scc1 p1_6220_3022
  v_max3_f32 v5, v196, v197, v5
  v_max3_f32 v6, v198, v199, v6
  v_max3_f32 v5, v200, v201, v5
  v_max3_f32 v6, v202, v203, v6
  v_max3_f32 v5, v204, v205, v5
  v_max3_f32 v6, v206, v207, v6
  v_max3_f32 v5, v208, v209, v5
  v_max3_f32 v6, v210, v211, v6
  s_cmp_lt_u32 s61, 7
  s_cbranch_scc1 p1_6220_3022
  v_max3_f32 v5, v148, v149, v5
  v_max3_f32 v6, v150, v151, v6
  v_max3_f32 v5, v152, v153, v5
  v_max3_f32 v6, v154, v155, v6
  v_max3_f32 v5, v156, v157, v5
  v_max3_f32 v6, v158, v159, v6
  v_max3_f32 v5, v160, v161, v5
  v_max3_f32 v6, v162, v163, v6
p1_6220_3022:
  v_max_f32 v5, v5, v6
  v_mov_b32 v6, v5
  s_nop 0
  s_nop 0
  v_permlane32_swap_b32 v6, v5
  v_max_f32 v5, v5, v6
  v_sub_f32 v10, 0, v5
  v_sub_f32 v11, 0, v5
  s_nop 1
  v_mov_b32 v180, v10
  v_mov_b32 v181, v10
  v_mov_b32 v182, v10
  v_mov_b32 v183, v10
  v_mov_b32 v184, v10
  v_mov_b32 v185, v10
  v_mov_b32 v186, v10
  v_mov_b32 v187, v10
  v_mov_b32 v188, v10
  v_mov_b32 v189, v10
  v_mov_b32 v190, v10
  v_mov_b32 v191, v10
  v_mov_b32 v192, v10
  v_mov_b32 v193, v10
  v_mov_b32 v194, v10
  v_mov_b32 v195, v10
  s_nop 0
  s_nop 0
  v_mfma_f32_32x32x16_bf16 v[148:163], v[56:59], v[20:23], v[180:195]
  v_add_f32 v212, v10, v212
  v_add_f32 v213, v10, v213
  v_add_f32 v214, v10, v214
  v_add_f32 v215, v10, v215
  v_add_f32 v216, v10, v216
  v_add_f32 v217, v10, v217
  v_add_f32 v218, v10, v218
  v_add_f32 v219, v10, v219
  v_add_f32 v220, v10, v220
  v_add_f32 v221, v10, v221
  v_add_f32 v222, v10, v222
  v_add_f32 v223, v10, v223
  v_add_f32 v224, v10, v224
  v_add_f32 v225, v10, v225
  v_add_f32 v226, v10, v226
  v_add_f32 v227, v10, v227
  v_mfma_f32_32x32x16_bf16 v[164:179], v[52:55], v[20:23], v[180:195]
  v_exp_f32 v212, v212
  v_exp_f32 v213, v213
  v_exp_f32 v214, v214
  v_exp_f32 v215, v215
  v_cvt_pk_bf16_f32 v212, v212, v213
  v_exp_f32 v216, v216
  v_exp_f32 v217, v217
  v_cvt_pk_bf16_f32 v213, v214, v215
  v_exp_f32 v218, v218
  v_exp_f32 v219, v219
  v_cvt_pk_bf16_f32 v214, v216, v217
  v_exp_f32 v220, v220
  v_exp_f32 v221, v221
  v_cvt_pk_bf16_f32 v215, v218, v219
  v_exp_f32 v222, v222
  v_exp_f32 v223, v223
  v_cvt_pk_bf16_f32 v216, v220, v221
  v_exp_f32 v224, v224
  v_exp_f32 v225, v225
  v_cvt_pk_bf16_f32 v217, v222, v223
  v_exp_f32 v226, v226
  v_exp_f32 v227, v227
  v_cvt_pk_bf16_f32 v218, v224, v225
  v_cvt_pk_bf16_f32 v219, v226, v227
  v_and_b32 v220, v12, v212
  v_and_b32 v221, v13, v213
  v_and_b32 v222, v14, v214
  v_and_b32 v223, v15, v215
  v_and_b32 v224, v16, v216
  v_and_b32 v225, v17, v217
  v_and_b32 v226, v18, v218
  v_and_b32 v227, v19, v219
  v_xor_b32 v212, v212, v220
  v_xor_b32 v213, v213, v221
  v_xor_b32 v214, v214, v222
  v_xor_b32 v215, v215, v223
  v_xor_b32 v216, v216, v224
  v_xor_b32 v217, v217, v225
  v_xor_b32 v218, v218, v226
  v_xor_b32 v219, v219, v227
  s_waitcnt vmcnt(18)
  v_mfma_f32_32x32x16_bf16 v[196:211], v[132:135], v[220:223], 0
  s_cmp_lt_u32 s61, 1
  s_cbranch_scc1 x_6220_3026
  v_mfma_f32_32x32x16_bf16 v[196:211], v[136:139], v[224:227], v[196:211]
  v_exp_f32 v148, v148
  v_exp_f32 v149, v149
  v_exp_f32 v150, v150
  v_exp_f32 v151, v151
  v_cvt_pk_bf16_f32 v148, v148, v149
  v_mfma_f32_32x32x16_bf16 v[196:211], v[68:71], v[212:215], v[196:211]
  v_exp_f32 v152, v152
  v_exp_f32 v153, v153
  v_cvt_pk_bf16_f32 v149, v150, v151
  v_exp_f32 v154, v154
  v_exp_f32 v155, v155
  v_cvt_pk_bf16_f32 v150, v152, v153
  v_mfma_f32_32x32x16_bf16 v[196:211], v[72:75], v[216:219], v[196:211]
  v_exp_f32 v156, v156
  v_exp_f32 v157, v157
  v_cvt_pk_bf16_f32 v151, v154, v155
  v_exp_f32 v158, v158
  v_exp_f32 v159, v159
  v_cvt_pk_bf16_f32 v152, v156, v157
  v_mfma_f32_32x32x16_bf16 v[212:227], v[48:51], v[20:23], v[180:195]
  v_exp_f32 v160, v160
  v_exp_f32 v161, v161
  v_cvt_pk_bf16_f32 v153, v158, v159
  v_exp_f32 v162, v162
  v_exp_f32 v163, v163
  v_cvt_pk_bf16_f32 v154, v160, v161
  v_cvt_pk_bf16_f32 v155, v162, v163
  s_cmp_lt_u32 s61, 2
  s_cbranch_scc1 x_6220_3027
  s_waitcnt vmcnt(16)
  v_mfma_f32_32x32x16_bf16 v[196:211], v[124:127], v[148:151], v[196:211]
  v_exp_f32 v164, v164
  v_exp_f32 v165, v165
  v_exp_f32 v166, v166
  v_exp_f32 v167, v167
  v_cvt_pk_bf16_f32 v164, v164, v165
  v_exp_f32 v168, v168
  v_mfma_f32_32x32x16_bf16 v[196:211], v[128:131], v[152:155], v[196:211]
  v_exp_f32 v169, v169
  v_cvt_pk_bf16_f32 v165, v166, v167
  v_exp_f32 v170, v170
  v_exp_f32 v171, v171
  v_cvt_pk_bf16_f32 v166, v168, v169
  v_exp_f32 v172, v172
  v_exp_f32 v173, v173
  v_cvt_pk_bf16_f32 v167, v170, v171
  v_mfma_f32_32x32x16_bf16 v[148:163], v[44:47], v[20:23], v[180:195]
  v_exp_f32 v174, v174
  v_exp_f32 v175, v175
  v_cvt_pk_bf16_f32 v168, v172, v173
  v_exp_f32 v176, v176
  v_exp_f32 v177, v177
  v_cvt_pk_bf16_f32 v169, v174, v175
  v_exp_f32 v178, v178
  v_exp_f32 v179, v179
  v_cvt_pk_bf16_f32 v170, v176, v177
  v_cvt_pk_bf16_f32 v171, v178, v179
  s_cmp_lt_u32 s61, 3
  s_cbranch_scc1 x_6220_3028
  s_waitcnt vmcnt(14)
  v_mfma_f32_32x32x16_bf16 v[196:211], v[116:119], v[164:167], v[196:211]
  v_exp_f32 v212, v212
  v_exp_f32 v213, v213
  v_exp_f32 v214, v214
  v_exp_f32 v215, v215
  v_cvt_pk_bf16_f32 v212, v212, v213
  v_exp_f32 v216, v216
  v_mfma_f32_32x32x16_bf16 v[196:211], v[120:123], v[168:171], v[196:211]
  v_exp_f32 v217, v217
  v_cvt_pk_bf16_f32 v213, v214, v215
  v_exp_f32 v218, v218
  v_exp_f32 v219, v219
  v_cvt_pk_bf16_f32 v214, v216, v217
  v_exp_f32 v220, v220
  v_exp_f32 v221, v221
  v_cvt_pk_bf16_f32 v215, v218, v219
  v_mfma_f32_32x32x16_bf16 v[164:179], v[40:43], v[20:23], v[180:195]
  v_exp_f32 v222, v222
  v_exp_f32 v223, v223
  v_cvt_pk_bf16_f32 v216, v220, v221
  v_exp_f32 v224, v224
  v_exp_f32 v225, v225
  v_cvt_pk_bf16_f32 v217, v222, v223
  v_exp_f32 v226, v226
  v_exp_f32 v227, v227
  v_cvt_pk_bf16_f32 v218, v224, v225
  v_cvt_pk_bf16_f32 v219, v226, v227
  s_cmp_lt_u32 s61, 4
  s_cbranch_scc1 x_6220_3029
  s_waitcnt vmcnt(12)
  v_mfma_f32_32x32x16_bf16 v[196:211], v[108:111], v[212:215], v[196:211]
  v_exp_f32 v148, v148
  v_exp_f32 v149, v149
  v_exp_f32 v150, v150
  v_exp_f32 v151, v151
  v_cvt_pk_bf16_f32 v148, v148, v149
  v_exp_f32 v152, v152
  v_mfma_f32_32x32x16_bf16 v[196:211], v[112:115], v[216:219], v[196:211]
  v_exp_f32 v153, v153
  v_cvt_pk_bf16_f32 v149, v150, v151
  v_exp_f32 v154, v154
  v_exp_f32 v155, v155
  v_cvt_pk_bf16_f32 v150, v152, v153
  v_exp_f32 v156, v156
  v_exp_f32 v157, v157
  v_cvt_pk_bf16_f32 v151, v154, v155
  v_mfma_f32_32x32x16_bf16 v[212:227], v[36:39], v[20:23], v[180:195]
  v_exp_f32 v158, v158
  v_exp_f32 v159, v159
  v_cvt_pk_bf16_f32 v152, v156, v157
  v_exp_f32 v160, v160
  v_exp_f32 v161, v161
  v_cvt_pk_bf16_f32 v153, v158, v159
  v_exp_f32 v162, v162
  v_exp_f32 v163, v163
  v_cvt_pk_bf16_f32 v154, v160, v161
  v_cvt_pk_bf16_f32 v155, v162, v163
  s_cmp_lt_u32 s61, 5
  s_cbranch_scc1 x_6220_3030
  s_waitcnt vmcnt(10)
  v_mfma_f32_32x32x16_bf16 v[196:211], v[100:103], v[148:151], v[196:211]
  v_exp_f32 v164, v164
  v_exp_f32 v165, v165
  v_exp_f32 v166, v166
  v_exp_f32 v167, v167
  v_cvt_pk_bf16_f32 v164, v164, v165
  v_exp_f32 v168, v168
  v_mfma_f32_32x32x16_bf16 v[196:211], v[104:107], v[152:155], v[196:211]
  v_exp_f32 v169, v169
  v_cvt_pk_bf16_f32 v165, v166, v167
  v_exp_f32 v170, v170
  v_exp_f32 v171, v171
  v_cvt_pk_bf16_f32 v166, v168, v169
  v_exp_f32 v172, v172
  v_exp_f32 v173, v173
  v_cvt_pk_bf16_f32 v167, v170, v171
  v_mfma_f32_32x32x16_bf16 v[148:163], v[32:35], v[20:23], v[180:195]
  v_exp_f32 v174, v174
  v_exp_f32 v175, v175
  v_cvt_pk_bf16_f32 v168, v172, v173
  v_exp_f32 v176, v176
  v_exp_f32 v177, v177
  v_cvt_pk_bf16_f32 v169, v174, v175
  v_exp_f32 v178, v178
  v_exp_f32 v179, v179
  v_cvt_pk_bf16_f32 v170, v176, v177
  v_cvt_pk_bf16_f32 v171, v178, v179
  s_cmp_lt_u32 s61, 6
  s_cbranch_scc1 x_6220_3031
  s_waitcnt vmcnt(8)
  v_mfma_f32_32x32x16_bf16 v[196:211], v[92:95], v[164:167], v[196:211]
  v_exp_f32 v212, v212
  v_exp_f32 v213, v213
  v_exp_f32 v214, v214
  v_exp_f32 v215, v215
  v_cvt_pk_bf16_f32 v212, v212, v213
  v_exp_f32 v216, v216
  v_mfma_f32_32x32x16_bf16 v[196:211], v[96:99], v[168:171], v[196:211]
  v_exp_f32 v217, v217
  v_cvt_pk_bf16_f32 v213, v214, v215
  v_exp_f32 v218, v218
  v_exp_f32 v219, v219
  v_cvt_pk_bf16_f32 v214, v216, v217
  v_exp_f32 v220, v220
  v_exp_f32 v221, v221
  v_cvt_pk_bf16_f32 v215, v218, v219
  v_exp_f32 v222, v222
  v_exp_f32 v223, v223
  v_cvt_pk_bf16_f32 v216, v220, v221
  v_exp_f32 v224, v224
  v_exp_f32 v225, v225
  v_cvt_pk_bf16_f32 v217, v222, v223
  v_exp_f32 v226, v226
  v_exp_f32 v227, v227
  v_cvt_pk_bf16_f32 v218, v224, v225
  v_cvt_pk_bf16_f32 v219, v226, v227
  s_cmp_lt_u32 s61, 7
  s_cbranch_scc1 x_6220_3032
  s_waitcnt vmcnt(6)
  v_mfma_f32_32x32x16_bf16 v[196:211], v[84:87], v[212:215], v[196:211]
  v_exp_f32 v148, v148
  v_exp_f32 v149, v149
  v_exp_f32 v150, v150
  v_exp_f32 v151, v151
  v_cvt_pk_bf16_f32 v148, v148, v149
  v_exp_f32 v152, v152
  v_mfma_f32_32x32x16_bf16 v[196:211], v[88:91], v[216:219], v[196:211]
  v_exp_f32 v153, v153
  v_cvt_pk_bf16_f32 v149, v150, v151
  v_exp_f32 v154, v154
  v_exp_f32 v155, v155
  v_cvt_pk_bf16_f32 v150, v152, v153
  v_exp_f32 v156, v156
  v_exp_f32 v157, v157
  v_cvt_pk_bf16_f32 v151, v154, v155
  v_exp_f32 v158, v158
  v_exp_f32 v159, v159
  v_cvt_pk_bf16_f32 v152, v156, v157
  v_exp_f32 v160, v160
  v_exp_f32 v161, v161
  v_cvt_pk_bf16_f32 v153, v158, v159
  v_exp_f32 v162, v162
  v_exp_f32 v163, v163
  v_cvt_pk_bf16_f32 v154, v160, v161
  v_cvt_pk_bf16_f32 v155, v162, v163
  s_waitcnt vmcnt(4)
  v_mfma_f32_32x32x16_bf16 v[196:211], v[76:79], v[148:151], v[196:211]
  v_mfma_f32_32x32x16_bf16 v[196:211], v[80:83], v[152:155], v[196:211]
p2_6220_3023:
  s_nop 13
  v_rcp_f32 v10, v204
  s_nop 0
  v_mov_b32 v11, v10
  v_mul_f32 v196, v10, v196
  v_mul_f32 v197, v10, v197
  v_mul_f32 v198, v10, v198
  v_mul_f32 v199, v10, v199
  v_mul_f32 v200, v10, v200
  v_mul_f32 v201, v10, v201
  v_mul_f32 v202, v10, v202
  v_mul_f32 v203, v10, v203
  v_cvt_pk_bf16_f32 v212, v196, v197
  v_cvt_pk_bf16_f32 v213, v198, v199
  v_cvt_pk_bf16_f32 v214, v200, v201
  v_cvt_pk_bf16_f32 v215, v202, v203
  buffer_store_dwordx4 v[212:215], v1, s[32:35], s60 offen sc1
  s_lshl_b32 s43, s46, 1
  s_add_u32 s43, s43, 1
  s_min_u32 s61, s43, 7
  s_waitcnt vmcnt(1)
  v_mfma_f32_32x32x16_bf16 v[148:163], v[32:35], v[24:27], 0
  v_mfma_f32_32x32x16_bf16 v[164:179], v[64:67], v[24:27], 0
  v_mfma_f32_32x32x16_bf16 v[180:195], v[60:63], v[24:27], 0
  v_mfma_f32_32x32x16_bf16 v[196:211], v[56:59], v[24:27], 0
  s_nop 7
  s_cmp_lt_u32 s43, 8
  s_cbranch_scc1 m1_6220_3035
  s_nop 0
  s_nop 0
  v_cndmask_b32 v212, v148, v164, s[64:65]
  v_cndmask_b32 v213, v149, v165, s[66:67]
  v_cndmask_b32 v214, v150, v166, s[68:69]
  v_cndmask_b32 v215, v151, v167, s[70:71]
  v_cndmask_b32 v216, v152, v168, s[72:73]
  v_cndmask_b32 v217, v153, v169, s[74:75]
  v_cndmask_b32 v218, v154, v170, s[76:77]
  v_cndmask_b32 v219, v155, v171, s[78:79]
  v_cndmask_b32 v220, v156, v172, s[80:81]
  v_cndmask_b32 v221, v157, v173, s[82:83]
  v_cndmask_b32 v222, v158, v174, s[84:85]
  v_cndmask_b32 v223, v159, v175, s[86:87]
  v_cndmask_b32 v224, v160, v176, s[88:89]
  v_cndmask_b32 v225, v161, v177, s[90:91]
  v_cndmask_b32 v226, v162, v178, s[92:93]
  v_cndmask_b32 v227, v163, v179, s[94:95]
m2_6220_3036:
  v_max_f32 v5, v212, v213
  v_max_f32 v6, v214, v215
  v_max3_f32 v5, v216, v217, v5
  v_max3_f32 v6, v218, v219, v6
  v_max3_f32 v5, v220, v221, v5
  v_max3_f32 v6, v222, v223, v6
  v_max3_f32 v5, v224, v225, v5
  v_max3_f32 v6, v226, v227, v6
  s_cmp_lt_u32 s61, 1
  s_cbranch_scc1 p1_6220_3033
  v_mfma_f32_32x32x16_bf16 v[148:163], v[52:55], v[24:27], 0
  v_max3_f32 v5, v180, v181, v5
  v_max3_f32 v6, v182, v183, v6
  v_max3_f32 v5, v184, v185, v5
  v_max3_f32 v6, v186, v187, v6
  v_max3_f32 v5, v188, v189, v5
  v_max3_f32 v6, v190, v191, v6
  v_max3_f32 v5, v192, v193, v5
  v_max3_f32 v6, v194, v195, v6
  s_cmp_lt_u32 s61, 2
  s_cbranch_scc1 p1_6220_3033
  v_mfma_f32_32x32x16_bf16 v[164:179], v[48:51], v[24:27], 0
  v_max3_f32 v5, v196, v197, v5
  v_max3_f32 v6, v198, v199, v6
  v_max3_f32 v5, v200, v201, v5
  v_max3_f32 v6, v202, v203, v6
  v_max3_f32 v5, v204, v205, v5
  v_max3_f32 v6, v206, v207, v6
  v_max3_f32 v5, v208, v209, v5
  v_max3_f32 v6, v210, v211, v6
  s_cmp_lt_u32 s61, 3
  s_cbranch_scc1 p1_6220_3033
  v_mfma_f32_32x32x16_bf16 v[180:195], v[44:47], v[24:27], 0
  v_max3_f32 v5, v148, v149, v5
  v_max3_f32 v6, v150, v151, v6
  v_max3_f32 v5, v152, v153, v5
  v_max3_f32 v6, v154, v155, v6
  v_max3_f32 v5, v156, v157, v5
  v_max3_f32 v6, v158, v159, v6
  v_max3_f32 v5, v160, v161, v5
  v_max3_f32 v6, v162, v163, v6
  s_cmp_lt_u32 s61, 4
  s_cbranch_scc1 p1_6220_3033
  v_mfma_f32_32x32x16_bf16 v[196:211], v[40:43], v[24:27], 0
  v_max3_f32 v5, v164, v165, v5
  v_max3_f32 v6, v166, v167, v6
  v_max3_f32 v5, v168, v169, v5
  v_max3_f32 v6, v170, v171, v6
  v_max3_f32 v5, v172, v173, v5
  v_max3_f32 v6, v174, v175, v6
  v_max3_f32 v5, v176, v177, v5
  v_max3_f32 v6, v178, v179, v6
  s_cmp_lt_u32 s61, 5
  s_cbranch_scc1 p1_6220_3033
  v_mfma_f32_32x32x16_bf16 v[148:163], v[36:39], v[24:27], 0
  v_max3_f32 v5, v180, v181, v5
  v_max3_f32 v6, v182, v183, v6
  v_max3_f32 v5, v184, v185, v5
  v_max3_f32 v6, v186, v187, v6
  v_max3_f32 v5, v188, v189, v5
  v_max3_f32 v6, v190, v191, v6
  v_max3_f32 v5, v192, v193, v5
  v_max3_f32 v6, v194, v195, v6
  s_cmp_lt_u32 s61, 6
  s_cbranch_scc1 p1_6220_3033
  v_max3_f32 v5, v196, v197, v5
  v_max3_f32 v6, v198, v199, v6
  v_max3_f32 v5, v200, v201, v5
  v_max3_f32 v6, v202, v203, v6
  v_max3_f32 v5, v204, v205, v5
  v_max3_f32 v6, v206, v207, v6
  v_max3_f32 v5, v208, v209, v5
  v_max3_f32 v6, v210, v211, v6
  s_cmp_lt_u32 s61, 7
  s_cbranch_scc1 p1_6220_3033
  v_max3_f32 v5, v148, v149, v5
  v_max3_f32 v6, v150, v151, v6
  v_max3_f32 v5, v152, v153, v5
  v_max3_f32 v6, v154, v155, v6
  v_max3_f32 v5, v156, v157, v5
  v_max3_f32 v6, v158, v159, v6
  v_max3_f32 v5, v160, v161, v5
  v_max3_f32 v6, v162, v163, v6
p1_6220_3033:
  v_max_f32 v5, v5, v6
  v_mov_b32 v6, v5
  s_nop 0
  s_nop 0
  v_permlane32_swap_b32 v6, v5
  v_max_f32 v5, v5, v6
  v_sub_f32 v10, 0, v5
  v_sub_f32 v11, 0, v5
  s_nop 1
  v_mov_b32 v180, v10
  v_mov_b32 v181, v10
  v_mov_b32 v182, v10
  v_mov_b32 v183, v10
  v_mov_b32 v184, v10
  v_mov_b32 v185, v10
  v_mov_b32 v186, v10
  v_mov_b32 v187, v10
  v_mov_b32 v188, v10
  v_mov_b32 v189, v10
  v_mov_b32 v190, v10
  v_mov_b32 v191, v10
  v_mov_b32 v192, v10
  v_mov_b32 v193, v10
  v_mov_b32 v194, v10
  v_mov_b32 v195, v10
  s_nop 0
  s_nop 0
  v_mfma_f32_32x32x16_bf16 v[148:163], v[60:63], v[24:27], v[180:195]
  v_add_f32 v212, v10, v212
  v_add_f32 v213, v10, v213
  v_add_f32 v214, v10, v214
  v_add_f32 v215, v10, v215
  v_add_f32 v216, v10, v216
  v_add_f32 v217, v10, v217
  v_add_f32 v218, v10, v218
  v_add_f32 v219, v10, v219
  v_add_f32 v220, v10, v220
  v_add_f32 v221, v10, v221
  v_add_f32 v222, v10, v222
  v_add_f32 v223, v10, v223
  v_add_f32 v224, v10, v224
  v_add_f32 v225, v10, v225
  v_add_f32 v226, v10, v226
  v_add_f32 v227, v10, v227
  v_mfma_f32_32x32x16_bf16 v[164:179], v[56:59], v[24:27], v[180:195]
  v_exp_f32 v212, v212
  v_exp_f32 v213, v213
  v_exp_f32 v214, v214
  v_exp_f32 v215, v215
  v_cvt_pk_bf16_f32 v212, v212, v213
  v_exp_f32 v216, v216
  v_exp_f32 v217, v217
  v_cvt_pk_bf16_f32 v213, v214, v215
  v_exp_f32 v218, v218
  v_exp_f32 v219, v219
  v_cvt_pk_bf16_f32 v214, v216, v217
  v_exp_f32 v220, v220
  v_exp_f32 v221, v221
  v_cvt_pk_bf16_f32 v215, v218, v219
  v_exp_f32 v222, v222
  v_exp_f32 v223, v223
  v_cvt_pk_bf16_f32 v216, v220, v221
  v_exp_f32 v224, v224
  v_exp_f32 v225, v225
  v_cvt_pk_bf16_f32 v217, v222, v223
  v_exp_f32 v226, v226
  v_exp_f32 v227, v227
  v_cvt_pk_bf16_f32 v218, v224, v225
  v_cvt_pk_bf16_f32 v219, v226, v227
  v_and_b32 v220, v12, v212
  v_and_b32 v221, v13, v213
  v_and_b32 v222, v14, v214
  v_and_b32 v223, v15, v215
  v_and_b32 v224, v16, v216
  v_and_b32 v225, v17, v217
  v_and_b32 v226, v18, v218
  v_and_b32 v227, v19, v219
  v_xor_b32 v212, v212, v220
  v_xor_b32 v213, v213, v221
  v_xor_b32 v214, v214, v222
  v_xor_b32 v215, v215, v223
  v_xor_b32 v216, v216, v224
  v_xor_b32 v217, v217, v225
  v_xor_b32 v218, v218, v226
  v_xor_b32 v219, v219, v227
  v_mfma_f32_32x32x16_bf16 v[196:211], v[140:143], v[220:223], 0
  s_cmp_lt_u32 s61, 1
  s_cbranch_scc1 x_6220_3037
  v_mfma_f32_32x32x16_bf16 v[196:211], v[144:147], v[224:227], v[196:211]
  v_exp_f32 v148, v148
  v_exp_f32 v149, v149
  v_exp_f32 v150, v150
  v_exp_f32 v151, v151
  v_cvt_pk_bf16_f32 v148, v148, v149
  v_mfma_f32_32x32x16_bf16 v[196:211], v[76:79], v[212:215], v[196:211]
  v_exp_f32 v152, v152
  v_exp_f32 v153, v153
  v_cvt_pk_bf16_f32 v149, v150, v151
  v_exp_f32 v154, v154
  v_exp_f32 v155, v155
  v_cvt_pk_bf16_f32 v150, v152, v153
  v_mfma_f32_32x32x16_bf16 v[196:211], v[80:83], v[216:219], v[196:211]
  v_exp_f32 v156, v156
  v_exp_f32 v157, v157
  v_cvt_pk_bf16_f32 v151, v154, v155
  v_exp_f32 v158, v158
  v_exp_f32 v159, v159
  v_cvt_pk_bf16_f32 v152, v156, v157
  v_mfma_f32_32x32x16_bf16 v[212:227], v[52:55], v[24:27], v[180:195]
  v_exp_f32 v160, v160
  v_exp_f32 v161, v161
  v_cvt_pk_bf16_f32 v153, v158, v159
  v_exp_f32 v162, v162
  v_exp_f32 v163, v163
  v_cvt_pk_bf16_f32 v154, v160, v161
  v_cvt_pk_bf16_f32 v155, v162, v163
  s_cmp_lt_u32 s61, 2
  s_cbranch_scc1 x_6220_3038
  v_mfma_f32_32x32x16_bf16 v[196:211], v[132:135], v[148:151], v[196:211]
  v_exp_f32 v164, v164
  v_exp_f32 v165, v165
  v_exp_f32 v166, v166
  v_exp_f32 v167, v167
  v_cvt_pk_bf16_f32 v164, v164, v165
  v_exp_f32 v168, v168
  v_mfma_f32_32x32x16_bf16 v[196:211], v[136:139], v[152:155], v[196:211]
  v_exp_f32 v169, v169
  v_cvt_pk_bf16_f32 v165, v166, v167
  v_exp_f32 v170, v170
  v_exp_f32 v171, v171
  v_cvt_pk_bf16_f32 v166, v168, v169
  v_exp_f32 v172, v172
  v_exp_f32 v173, v173
  v_cvt_pk_bf16_f32 v167, v170, v171
  v_mfma_f32_32x32x16_bf16 v[148:163], v[48:51], v[24:27], v[180:195]
  v_exp_f32 v174, v174
  v_exp_f32 v175, v175
  v_cvt_pk_bf16_f32 v168, v172, v173
  v_exp_f32 v176, v176
  v_exp_f32 v177, v177
  v_cvt_pk_bf16_f32 v169, v174, v175
  v_exp_f32 v178, v178
  v_exp_f32 v179, v179
  v_cvt_pk_bf16_f32 v170, v176, v177
  v_cvt_pk_bf16_f32 v171, v178, v179
  s_cmp_lt_u32 s61, 3
  s_cbranch_scc1 x_6220_3039
  v_mfma_f32_32x32x16_bf16 v[196:211], v[124:127], v[164:167], v[196:211]
  v_exp_f32 v212, v212
  v_exp_f32 v213, v213
  v_exp_f32 v214, v214
  v_exp_f32 v215, v215
  v_cvt_pk_bf16_f32 v212, v212, v213
  v_exp_f32 v216, v216
  v_mfma_f32_32x32x16_bf16 v[196:211], v[128:131], v[168:171], v[196:211]
  v_exp_f32 v217, v217
  v_cvt_pk_bf16_f32 v213, v214, v215
  v_exp_f32 v218, v218
  v_exp_f32 v219, v219
  v_cvt_pk_bf16_f32 v214, v216, v217
  v_exp_f32 v220, v220
  v_exp_f32 v221, v221
  v_cvt_pk_bf16_f32 v215, v218, v219
  v_mfma_f32_32x32x16_bf16 v[164:179], v[44:47], v[24:27], v[180:195]
  v_exp_f32 v222, v222
  v_exp_f32 v223, v223
  v_cvt_pk_bf16_f32 v216, v220, v221
  v_exp_f32 v224, v224
  v_exp_f32 v225, v225
  v_cvt_pk_bf16_f32 v217, v222, v223
  v_exp_f32 v226, v226
  v_exp_f32 v227, v227
  v_cvt_pk_bf16_f32 v218, v224, v225
  v_cvt_pk_bf16_f32 v219, v226, v227
  s_cmp_lt_u32 s61, 4
  s_cbranch_scc1 x_6220_3040
  v_mfma_f32_32x32x16_bf16 v[196:211], v[116:119], v[212:215], v[196:211]
  v_exp_f32 v148, v148
  v_exp_f32 v149, v149
  v_exp_f32 v150, v150
  v_exp_f32 v151, v151
  v_cvt_pk_bf16_f32 v148, v148, v149
  v_exp_f32 v152, v152
  v_mfma_f32_32x32x16_bf16 v[196:211], v[120:123], v[216:219], v[196:211]
  v_exp_f32 v153, v153
  v_cvt_pk_bf16_f32 v149, v150, v151
  v_exp_f32 v154, v154
  v_exp_f32 v155, v155
  v_cvt_pk_bf16_f32 v150, v152, v153
  v_exp_f32 v156, v156
  v_exp_f32 v157, v157
  v_cvt_pk_bf16_f32 v151, v154, v155
  v_mfma_f32_32x32x16_bf16 v[212:227], v[40:43], v[24:27], v[180:195]
  v_exp_f32 v158, v158
  v_exp_f32 v159, v159
  v_cvt_pk_bf16_f32 v152, v156, v157
  v_exp_f32 v160, v160
  v_exp_f32 v161, v161
  v_cvt_pk_bf16_f32 v153, v158, v159
  v_exp_f32 v162, v162
  v_exp_f32 v163, v163
  v_cvt_pk_bf16_f32 v154, v160, v161
  v_cvt_pk_bf16_f32 v155, v162, v163
  s_cmp_lt_u32 s61, 5
  s_cbranch_scc1 x_6220_3041
  v_mfma_f32_32x32x16_bf16 v[196:211], v[108:111], v[148:151], v[196:211]
  v_exp_f32 v164, v164
  v_exp_f32 v165, v165
  v_exp_f32 v166, v166
  v_exp_f32 v167, v167
  v_cvt_pk_bf16_f32 v164, v164, v165
  v_exp_f32 v168, v168
  v_mfma_f32_32x32x16_bf16 v[196:211], v[112:115], v[152:155], v[196:211]
  v_exp_f32 v169, v169
  v_cvt_pk_bf16_f32 v165, v166, v167
  v_exp_f32 v170, v170
  v_exp_f32 v171, v171
  v_cvt_pk_bf16_f32 v166, v168, v169
  v_exp_f32 v172, v172
  v_exp_f32 v173, v173
  v_cvt_pk_bf16_f32 v167, v170, v171
  v_mfma_f32_32x32x16_bf16 v[148:163], v[36:39], v[24:27], v[180:195]
  v_exp_f32 v174, v174
  v_exp_f32 v175, v175
  v_cvt_pk_bf16_f32 v168, v172, v173
  v_exp_f32 v176, v176
  v_exp_f32 v177, v177
  v_cvt_pk_bf16_f32 v169, v174, v175
  v_exp_f32 v178, v178
  v_exp_f32 v179, v179
  v_cvt_pk_bf16_f32 v170, v176, v177
  v_cvt_pk_bf16_f32 v171, v178, v179
  s_cmp_lt_u32 s61, 6
  s_cbranch_scc1 x_6220_3042
  v_mfma_f32_32x32x16_bf16 v[196:211], v[100:103], v[164:167], v[196:211]
  v_exp_f32 v212, v212
  v_exp_f32 v213, v213
  v_exp_f32 v214, v214
  v_exp_f32 v215, v215
  v_cvt_pk_bf16_f32 v212, v212, v213
  v_exp_f32 v216, v216
  v_mfma_f32_32x32x16_bf16 v[196:211], v[104:107], v[168:171], v[196:211]
  v_exp_f32 v217, v217
  v_cvt_pk_bf16_f32 v213, v214, v215
  v_exp_f32 v218, v218
  v_exp_f32 v219, v219
  v_cvt_pk_bf16_f32 v214, v216, v217
  v_exp_f32 v220, v220
  v_exp_f32 v221, v221
  v_cvt_pk_bf16_f32 v215, v218, v219
  v_exp_f32 v222, v222
  v_exp_f32 v223, v223
  v_cvt_pk_bf16_f32 v216, v220, v221
  v_exp_f32 v224, v224
  v_exp_f32 v225, v225
  v_cvt_pk_bf16_f32 v217, v222, v223
  v_exp_f32 v226, v226
  v_exp_f32 v227, v227
  v_cvt_pk_bf16_f32 v218, v224, v225
  v_cvt_pk_bf16_f32 v219, v226, v227
  s_cmp_lt_u32 s61, 7
  s_cbranch_scc1 x_6220_3043
  v_mfma_f32_32x32x16_bf16 v[196:211], v[92:95], v[212:215], v[196:211]
  v_exp_f32 v148, v148
  v_exp_f32 v149, v149
  v_exp_f32 v150, v150
  v_exp_f32 v151, v151
  v_cvt_pk_bf16_f32 v148, v148, v149
  v_exp_f32 v152, v152
  v_mfma_f32_32x32x16_bf16 v[196:211], v[96:99], v[216:219], v[196:211]
  v_exp_f32 v153, v153
  v_cvt_pk_bf16_f32 v149, v150, v151
  v_exp_f32 v154, v154
  v_exp_f32 v155, v155
  v_cvt_pk_bf16_f32 v150, v152, v153
  v_exp_f32 v156, v156
  v_exp_f32 v157, v157
  v_cvt_pk_bf16_f32 v151, v154, v155
  v_exp_f32 v158, v158
  v_exp_f32 v159, v159
  v_cvt_pk_bf16_f32 v152, v156, v157
  v_exp_f32 v160, v160
  v_exp_f32 v161, v161
  v_cvt_pk_bf16_f32 v153, v158, v159
  v_exp_f32 v162, v162
  v_exp_f32 v163, v163
  v_cvt_pk_bf16_f32 v154, v160, v161
  v_cvt_pk_bf16_f32 v155, v162, v163
  v_mfma_f32_32x32x16_bf16 v[196:211], v[84:87], v[148:151], v[196:211]
  s_nop 0
  v_mfma_f32_32x32x16_bf16 v[196:211], v[88:91], v[152:155], v[196:211]
p2_6220_3034:
  s_nop 13
  v_rcp_f32 v10, v204
  s_nop 0
  v_mov_b32 v11, v10
  v_mul_f32 v196, v10, v196
  v_mul_f32 v197, v10, v197
  v_mul_f32 v198, v10, v198
  v_mul_f32 v199, v10, v199
  v_mul_f32 v200, v10, v200
  v_mul_f32 v201, v10, v201
  v_mul_f32 v202, v10, v202
  v_mul_f32 v203, v10, v203
  v_cvt_pk_bf16_f32 v212, v196, v197
  v_cvt_pk_bf16_f32 v213, v198, v199
  v_cvt_pk_bf16_f32 v214, v200, v201
  v_cvt_pk_bf16_f32 v215, v202, v203
  buffer_store_dwordx4 v[212:215], v1, s[32:35], s60 offen offset:1024 sc1
  s_lshl_b32 s78, s2, 7
  s_add_u32 s78, s78, 14745600
  s_bfe_u32 s42, s2, 131073
  s_lshl_b32 s42, s42, 3
  s_bfe_u32 s43, s2, 196611
  s_add_u32 s76, s42, s43
  s_and_b32 s43, s2, 1
  s_lshl_b32 s43, s43, 2
  s_lshr_b32 s77, s2, 6
  s_add_u32 s77, s77, s43
  s_lshl_b32 s42, s76, 16
  s_add_u32 s43, s42, 12582912
  s_add_u32 s64, s22, s43
  s_addc_u32 s65, s23, 0
  s_mov_b32 s66, 65536
  s_mov_b32 s67, 131072
  s_add_u32 s68, s4, s42
  s_addc_u32 s69, s5, 0
  s_mov_b32 s70, 65536
  s_mov_b32 s71, 131072
  s_add_u32 s72, s18, s42
  s_addc_u32 s73, s19, 0
  s_mov_b32 s74, 65536
  s_mov_b32 s75, 131072
  v_lshrrev_b32 v3, 5, v0
  v_lshlrev_b32 v3, 2, v3
  v_bfe_u32 v4, v0, 2, 2
  v_add_u32 v3, v3, v4
  v_and_b32 v5, 3, v0
  v_lshlrev_b32 v5, 3, v5
  v_lshl_add_u32 v3, v3, 7, v5
  v_lshrrev_b32 v4, 1, v4
  v_bfe_u32 v5, v0, 4, 1
  v_lshl_add_u32 v4, v4, 1, v5
  v_lshl_add_u32 v3, v4, 5, v3
  s_and_b32 s42, s37, 1
  s_lshl_b32 s42, s42, 6
  v_xor_b32 v3, s42, v3
  s_lshl_b32 s43, s42, 9
  s_add_u32 s43, s43, 73728
  v_add_u32 v15, s43, v3
  v_xor_b32 v16, 64, v15
  s_lshl_b32 s43, s42, 3
  s_lshl_b32 s42, s76, 10
  s_add_u32 s42, s42, s43
  s_add_u32 s42, s42, 14745600
  v_and_b32 v3, 3, v0
  v_lshlrev_b32 v3, 7, v3
  v_add_u32 v12, s42, v3
  s_lshl_b32 s42, s37, 12
  v_add_u32 v19, s42, v1
  v_add_u32 v8, 36864, v19
  v_add_u32 v17, 139264, v19
  v_xor_b32 v18, 4096, v19
  v_add_u32 v18, 139264, v18
  s_lshr_b32 s42, s37, 1
  s_and_b32 s43, s37, 1
  s_lshl_b32 s43, s43, 5
  s_add_u32 s43, s43, s42
  s_lshl_b32 s43, s43, 10
  v_add_u32 v13, s43, v1
  s_lshl_b32 s42, s42, 15
  s_lshl_b32 s43, s77, 7
  s_add_u32 s42, s42, s43
  s_and_b32 s43, s37, 1
  s_lshl_b32 s43, s43, 6
  s_add_u32 s42, s42, s43
  v_and_b32 v3, 31, v0
  v_lshlrev_b32 v3, 10, v3
  v_lshrrev_b32 v4, 5, v0
  v_lshl_add_u32 v3, v4, 4, v3
  v_add_u32 v14, s42, v3
  s_waitcnt vmcnt(0)
  v_mov_b32 v3, 163768
  v_mov_b32 v4, 1
  s_mov_b64 exec, 1
  ds_add_rtn_u32 v5, v3, v4
  s_waitcnt lgkmcnt(0)
  v_readfirstlane_b32 s48, v5
  s_nop 0
  s_cmp_lg_u32 s48, 3
  s_cbranch_scc1 nf_6220_3044
  buffer_store_dwordx2 v[252:253], v254, s[32:35], s78 offen sc1
nf_6220_3044:
  s_mov_b64 exec, -1
  s_setprio 0
  buffer_load_dwordx4 v[20:23], v14, s[68:71], 0 offen
  buffer_load_dwordx4 v[24:27], v14, s[68:71], 0 offen offset:32
  ds_read_b128 v[160:163], v9 offset:32
  s_waitcnt vmcnt(0)
  v_lshlrev_b32 v124, 16, v20
  v_and_b32 v125, 0xffff0000, v20
  v_lshlrev_b32 v126, 16, v21
  v_and_b32 v127, 0xffff0000, v21
  v_lshlrev_b32 v128, 16, v22
  v_and_b32 v129, 0xffff0000, v22
  v_lshlrev_b32 v130, 16, v23
  v_and_b32 v131, 0xffff0000, v23
  v_lshlrev_b32 v132, 16, v24
  v_and_b32 v133, 0xffff0000, v24
  v_lshlrev_b32 v134, 16, v25
  v_and_b32 v135, 0xffff0000, v25
  v_lshlrev_b32 v136, 16, v26
  v_and_b32 v137, 0xffff0000, v26
  v_lshlrev_b32 v138, 16, v27
  v_and_b32 v139, 0xffff0000, v27
  v_permlane32_swap_b32 v124, v128
  v_permlane32_swap_b32 v125, v129
  v_permlane32_swap_b32 v126, v130
  v_permlane32_swap_b32 v127, v131
  v_permlane32_swap_b32 v132, v136
  v_permlane32_swap_b32 v133, v137
  v_permlane32_swap_b32 v134, v138
  v_permlane32_swap_b32 v135, v139
  s_waitcnt lgkmcnt(0)
lsp_6220_3045:
  v_min3_u32 v160, v160, v161, v162
  v_min_u32 v160, v160, v163
  v_cmp_gt_u32 vcc, 1, v160
  s_nop 4
  s_cbranch_vccz lok_6220_3046
  s_add_u32 s3, s3, 1
  s_cmp_gt_u32 s3, 4194304
  s_cbranch_scc1 lok_6220_3046
  s_sleep 4
  ds_read_b128 v[160:163], v9 offset:32
  s_waitcnt lgkmcnt(0)
  s_branch lsp_6220_3045
lok_6220_3046:
  buffer_load_dwordx2 v[156:157], v12, s[32:35], 0 offen sc1
  s_waitcnt vmcnt(0)
poll_6220_3047:
  v_cmp_ne_u64 vcc, v[156:157], v[252:253]
  s_nop 4
  s_cbranch_vccz pok_6220_3048
  s_add_u32 s3, s3, 1
  s_cmp_gt_u32 s3, 4194304
  s_cbranch_scc1 pok_6220_3048
  s_sleep 8
  buffer_load_dwordx2 v[156:157], v12, s[32:35], 0 offen sc1
  s_waitcnt vmcnt(0)
  s_branch poll_6220_3047
pok_6220_3048:
  buffer_load_dwordx4 v[28:31], v13, s[64:67], 0 offen sc1
  buffer_load_dwordx4 v[32:35], v13, s[64:67], 0 offen offset:2048 sc1
  s_mov_b32 s60, 4096
  buffer_load_dwordx4 v[36:39], v13, s[64:67], s60 offen sc1
  buffer_load_dwordx4 v[40:43], v13, s[64:67], s60 offen offset:2048 sc1
  s_mov_b32 s60, 8192
  buffer_load_dwordx4 v[44:47], v13, s[64:67], s60 offen sc1
  buffer_load_dwordx4 v[48:51], v13, s[64:67], s60 offen offset:2048 sc1
  s_mov_b32 s60, 12288
  buffer_load_dwordx4 v[52:55], v13, s[64:67], s60 offen sc1
  buffer_load_dwordx4 v[56:59], v13, s[64:67], s60 offen offset:2048 sc1
  s_mov_b32 s60, 16384
  buffer_load_dwordx4 v[60:63], v13, s[64:67], s60 offen sc1
  buffer_load_dwordx4 v[64:67], v13, s[64:67], s60 offen offset:2048 sc1
  s_mov_b32 s60, 20480
  buffer_load_dwordx4 v[68:71], v13, s[64:67], s60 offen sc1
  buffer_load_dwordx4 v[72:75], v13, s[64:67], s60 offen offset:2048 sc1
  s_mov_b32 s60, 24576
  buffer_load_dwordx4 v[76:79], v13, s[64:67], s60 offen sc1
  buffer_load_dwordx4 v[80:83], v13, s[64:67], s60 offen offset:2048 sc1
  s_mov_b32 s60, 28672
  buffer_load_dwordx4 v[84:87], v13, s[64:67], s60 offen sc1
  buffer_load_dwordx4 v[88:91], v13, s[64:67], s60 offen offset:2048 sc1
  ds_read_b64_tr_b16 v[92:93], v15 offset:0
  ds_read_b64_tr_b16 v[94:95], v15 offset:1024
  ds_read_b64_tr_b16 v[96:97], v16 offset:0
  ds_read_b64_tr_b16 v[98:99], v16 offset:1024
  ds_read_b64_tr_b16 v[100:101], v15 offset:2048
  ds_read_b64_tr_b16 v[102:103], v15 offset:3072
  ds_read_b64_tr_b16 v[104:105], v16 offset:2048
  ds_read_b64_tr_b16 v[106:107], v16 offset:3072
  ds_read_b64_tr_b16 v[108:109], v15 offset:4096
  ds_read_b64_tr_b16 v[110:111], v15 offset:5120
  ds_read_b64_tr_b16 v[112:113], v16 offset:4096
  ds_read_b64_tr_b16 v[114:115], v16 offset:5120
  ds_read_b64_tr_b16 v[116:117], v15 offset:6144
  ds_read_b64_tr_b16 v[118:119], v15 offset:7168
  ds_read_b64_tr_b16 v[120:121], v16 offset:6144
  ds_read_b64_tr_b16 v[122:123], v16 offset:7168
  s_waitcnt vmcnt(15) lgkmcnt(12)
  v_mfma_f32_32x32x16_bf16 v[140:155], v[96:99], v[28:31], 0
  v_mfma_f32_32x32x16_bf16 v[124:139], v[92:95], v[28:31], v[124:139]
  ds_read_b64_tr_b16 v[92:93], v15 offset:8192
  ds_read_b64_tr_b16 v[94:95], v15 offset:9216
  ds_read_b64_tr_b16 v[96:97], v16 offset:8192
  ds_read_b64_tr_b16 v[98:99], v16 offset:9216
  s_waitcnt vmcnt(14) lgkmcnt(12)
  v_mfma_f32_32x32x16_bf16 v[140:155], v[104:107], v[32:35], v[140:155]
  v_mfma_f32_32x32x16_bf16 v[124:139], v[100:103], v[32:35], v[124:139]
  ds_read_b64_tr_b16 v[100:101], v15 offset:10240
  ds_read_b64_tr_b16 v[102:103], v15 offset:11264
  ds_read_b64_tr_b16 v[104:105], v16 offset:10240
  ds_read_b64_tr_b16 v[106:107], v16 offset:11264
  s_waitcnt vmcnt(13) lgkmcnt(12)
  v_mfma_f32_32x32x16_bf16 v[140:155], v[112:115], v[36:39], v[140:155]
  v_mfma_f32_32x32x16_bf16 v[124:139], v[108:111], v[36:39], v[124:139]
  ds_read_b64_tr_b16 v[108:109], v15 offset:12288
  ds_read_b64_tr_b16 v[110:111], v15 offset:13312
  ds_read_b64_tr_b16 v[112:113], v16 offset:12288
  ds_read_b64_tr_b16 v[114:115], v16 offset:13312
  s_waitcnt vmcnt(12) lgkmcnt(12)
  v_mfma_f32_32x32x16_bf16 v[140:155], v[120:123], v[40:43], v[140:155]
  v_mfma_f32_32x32x16_bf16 v[124:139], v[116:119], v[40:43], v[124:139]
  ds_read_b64_tr_b16 v[116:117], v15 offset:14336
  ds_read_b64_tr_b16 v[118:119], v15 offset:15360
  ds_read_b64_tr_b16 v[120:121], v16 offset:14336
  ds_read_b64_tr_b16 v[122:123], v16 offset:15360
  s_waitcnt vmcnt(11) lgkmcnt(12)
  v_mfma_f32_32x32x16_bf16 v[140:155], v[96:99], v[44:47], v[140:155]
  v_mfma_f32_32x32x16_bf16 v[124:139], v[92:95], v[44:47], v[124:139]
  ds_read_b64_tr_b16 v[92:93], v15 offset:16384
  ds_read_b64_tr_b16 v[94:95], v15 offset:17408
  ds_read_b64_tr_b16 v[96:97], v16 offset:16384
  ds_read_b64_tr_b16 v[98:99], v16 offset:17408
  s_waitcnt vmcnt(10) lgkmcnt(12)
  v_mfma_f32_32x32x16_bf16 v[140:155], v[104:107], v[48:51], v[140:155]
  v_mfma_f32_32x32x16_bf16 v[124:139], v[100:103], v[48:51], v[124:139]
  ds_read_b64_tr_b16 v[100:101], v15 offset:18432
  ds_read_b64_tr_b16 v[102:103], v15 offset:19456
  ds_read_b64_tr_b16 v[104:105], v16 offset:18432
  ds_read_b64_tr_b16 v[106:107], v16 offset:19456
  s_waitcnt vmcnt(9) lgkmcnt(12)
  v_mfma_f32_32x32x16_bf16 v[140:155], v[112:115], v[52:55], v[140:155]
  v_mfma_f32_32x32x16_bf16 v[124:139], v[108:111], v[52:55], v[124:139]
  ds_read_b64_tr_b16 v[108:109], v15 offset:20480
  ds_read_b64_tr_b16 v[110:111], v15 offset:21504
  ds_read_b64_tr_b16 v[112:113], v16 offset:20480
  ds_read_b64_tr_b16 v[114:115], v16 offset:21504
  s_waitcnt vmcnt(8) lgkmcnt(12)
  v_mfma_f32_32x32x16_bf16 v[140:155], v[120:123], v[56:59], v[140:155]
  v_mfma_f32_32x32x16_bf16 v[124:139], v[116:119], v[56:59], v[124:139]
  ds_read_b64_tr_b16 v[116:117], v15 offset:22528
  ds_read_b64_tr_b16 v[118:119], v15 offset:23552
  ds_read_b64_tr_b16 v[120:121], v16 offset:22528
  ds_read_b64_tr_b16 v[122:123], v16 offset:23552
  s_waitcnt vmcnt(7) lgkmcnt(12)
  v_mfma_f32_32x32x16_bf16 v[140:155], v[96:99], v[60:63], v[140:155]
  v_mfma_f32_32x32x16_bf16 v[124:139], v[92:95], v[60:63], v[124:139]
  ds_read_b64_tr_b16 v[92:93], v15 offset:24576
  ds_read_b64_tr_b16 v[94:95], v15 offset:25600
  ds_read_b64_tr_b16 v[96:97], v16 offset:24576
  ds_read_b64_tr_b16 v[98:99], v16 offset:25600
  s_waitcnt vmcnt(6) lgkmcnt(12)
  v_mfma_f32_32x32x16_bf16 v[140:155], v[104:107], v[64:67], v[140:155]
  v_mfma_f32_32x32x16_bf16 v[124:139], v[100:103], v[64:67], v[124:139]
  ds_read_b64_tr_b16 v[100:101], v15 offset:26624
  ds_read_b64_tr_b16 v[102:103], v15 offset:27648
  ds_read_b64_tr_b16 v[104:105], v16 offset:26624
  ds_read_b64_tr_b16 v[106:107], v16 offset:27648
  s_waitcnt vmcnt(5) lgkmcnt(12)
  v_mfma_f32_32x32x16_bf16 v[140:155], v[112:115], v[68:71], v[140:155]
  v_mfma_f32_32x32x16_bf16 v[124:139], v[108:111], v[68:71], v[124:139]
  ds_read_b64_tr_b16 v[108:109], v15 offset:28672
  ds_read_b64_tr_b16 v[110:111], v15 offset:29696
  ds_read_b64_tr_b16 v[112:113], v16 offset:28672
  ds_read_b64_tr_b16 v[114:115], v16 offset:29696
  s_waitcnt vmcnt(4) lgkmcnt(12)
  v_mfma_f32_32x32x16_bf16 v[140:155], v[120:123], v[72:75], v[140:155]
  v_mfma_f32_32x32x16_bf16 v[124:139], v[116:119], v[72:75], v[124:139]
  ds_read_b64_tr_b16 v[116:117], v15 offset:30720
  ds_read_b64_tr_b16 v[118:119], v15 offset:31744
  ds_read_b64_tr_b16 v[120:121], v16 offset:30720
  ds_read_b64_tr_b16 v[122:123], v16 offset:31744
  s_waitcnt vmcnt(3) lgkmcnt(12)
  v_mfma_f32_32x32x16_bf16 v[140:155], v[96:99], v[76:79], v[140:155]
  v_mfma_f32_32x32x16_bf16 v[124:139], v[92:95], v[76:79], v[124:139]
  s_waitcnt vmcnt(2) lgkmcnt(8)
  v_mfma_f32_32x32x16_bf16 v[140:155], v[104:107], v[80:83], v[140:155]
  v_mfma_f32_32x32x16_bf16 v[124:139], v[100:103], v[80:83], v[124:139]
  s_waitcnt vmcnt(1) lgkmcnt(4)
  v_mfma_f32_32x32x16_bf16 v[140:155], v[112:115], v[84:87], v[140:155]
  v_mfma_f32_32x32x16_bf16 v[124:139], v[108:111], v[84:87], v[124:139]
  s_waitcnt vmcnt(0) lgkmcnt(0)
  v_mfma_f32_32x32x16_bf16 v[140:155], v[120:123], v[88:91], v[140:155]
  v_mfma_f32_32x32x16_bf16 v[124:139], v[116:119], v[88:91], v[124:139]
  s_nop 12
  ds_write_b128 v17, v[140:143] offset:0
  ds_write_b128 v17, v[144:147] offset:1024
  ds_write_b128 v17, v[148:151] offset:2048
  ds_write_b128 v17, v[152:155] offset:3072
  s_waitcnt lgkmcnt(0)
  s_barrier
  ds_read_b128 v[156:159], v19 offset:0
  ds_read_b128 v[160:163], v19 offset:18432
  ds_read_b128 v[164:167], v8 offset:0
  ds_read_b128 v[168:171], v8 offset:18432
  ds_read_b128 v[172:175], v18 offset:0
  ds_read_b128 v[176:179], v19 offset:1024
  ds_read_b128 v[180:183], v19 offset:19456
  ds_read_b128 v[184:187], v8 offset:1024
  ds_read_b128 v[188:191], v8 offset:19456
  ds_read_b128 v[192:195], v18 offset:1024
  ds_read_b128 v[196:199], v19 offset:2048
  ds_read_b128 v[200:203], v19 offset:20480
  ds_read_b128 v[204:207], v8 offset:2048
  ds_read_b128 v[208:211], v8 offset:20480
  ds_read_b128 v[212:215], v18 offset:2048
  ds_read_b128 v[216:219], v19 offset:3072
  ds_read_b128 v[220:223], v19 offset:21504
  ds_read_b128 v[224:227], v8 offset:3072
  ds_read_b128 v[228:231], v8 offset:21504
  ds_read_b128 v[232:235], v18 offset:3072
  s_waitcnt lgkmcnt(15)
  v_add_f32 v156, v156, v160
  v_add_f32 v164, v164, v168
  v_add_f32 v124, v124, v172
  v_add_f32 v157, v157, v161
  v_add_f32 v165, v165, v169
  v_add_f32 v125, v125, v173
  v_add_f32 v158, v158, v162
  v_add_f32 v166, v166, v170
  v_add_f32 v126, v126, v174
  v_add_f32 v159, v159, v163
  v_add_f32 v167, v167, v171
  v_add_f32 v127, v127, v175
  v_add_f32 v156, v156, v164
  v_add_f32 v157, v157, v165
  v_add_f32 v158, v158, v166
  v_add_f32 v159, v159, v167
  v_add_f32 v124, v124, v156
  v_add_f32 v125, v125, v157
  v_add_f32 v126, v126, v158
  v_add_f32 v127, v127, v159
  v_cvt_pk_bf16_f32 v236, v124, v125
  v_cvt_pk_bf16_f32 v237, v126, v127
  s_waitcnt lgkmcnt(10)
  v_add_f32 v176, v176, v180
  v_add_f32 v184, v184, v188
  v_add_f32 v128, v128, v192
  v_add_f32 v177, v177, v181
  v_add_f32 v185, v185, v189
  v_add_f32 v129, v129, v193
  v_add_f32 v178, v178, v182
  v_add_f32 v186, v186, v190
  v_add_f32 v130, v130, v194
  v_add_f32 v179, v179, v183
  v_add_f32 v187, v187, v191
  v_add_f32 v131, v131, v195
  v_add_f32 v176, v176, v184
  v_add_f32 v177, v177, v185
  v_add_f32 v178, v178, v186
  v_add_f32 v179, v179, v187
  v_add_f32 v128, v128, v176
  v_add_f32 v129, v129, v177
  v_add_f32 v130, v130, v178
  v_add_f32 v131, v131, v179
  v_cvt_pk_bf16_f32 v238, v128, v129
  v_cvt_pk_bf16_f32 v239, v130, v131
  s_nop 0
  v_permlane32_swap_b32 v236, v238
  v_permlane32_swap_b32 v237, v239
  buffer_store_dwordx4 v[236:239], v14, s[72:75], 0 offen
  s_waitcnt lgkmcnt(5)
  v_add_f32 v196, v196, v200
  v_add_f32 v204, v204, v208
  v_add_f32 v132, v132, v212
  v_add_f32 v197, v197, v201
  v_add_f32 v205, v205, v209
  v_add_f32 v133, v133, v213
  v_add_f32 v198, v198, v202
  v_add_f32 v206, v206, v210
  v_add_f32 v134, v134, v214
  v_add_f32 v199, v199, v203
  v_add_f32 v207, v207, v211
  v_add_f32 v135, v135, v215
  v_add_f32 v196, v196, v204
  v_add_f32 v197, v197, v205
  v_add_f32 v198, v198, v206
  v_add_f32 v199, v199, v207
  v_add_f32 v132, v132, v196
  v_add_f32 v133, v133, v197
  v_add_f32 v134, v134, v198
  v_add_f32 v135, v135, v199
  v_cvt_pk_bf16_f32 v240, v132, v133
  v_cvt_pk_bf16_f32 v241, v134, v135
  s_waitcnt lgkmcnt(0)
  v_add_f32 v216, v216, v220
  v_add_f32 v224, v224, v228
  v_add_f32 v136, v136, v232
  v_add_f32 v217, v217, v221
  v_add_f32 v225, v225, v229
  v_add_f32 v137, v137, v233
  v_add_f32 v218, v218, v222
  v_add_f32 v226, v226, v230
  v_add_f32 v138, v138, v234
  v_add_f32 v219, v219, v223
  v_add_f32 v227, v227, v231
  v_add_f32 v139, v139, v235
  v_add_f32 v216, v216, v224
  v_add_f32 v217, v217, v225
  v_add_f32 v218, v218, v226
  v_add_f32 v219, v219, v227
  v_add_f32 v136, v136, v216
  v_add_f32 v137, v137, v217
  v_add_f32 v138, v138, v218
  v_add_f32 v139, v139, v219
  v_cvt_pk_bf16_f32 v242, v136, v137
  v_cvt_pk_bf16_f32 v243, v138, v139
  s_nop 0
  v_permlane32_swap_b32 v240, v242
  v_permlane32_swap_b32 v241, v243
  buffer_store_dwordx4 v[240:243], v14, s[72:75], 0 offen offset:32
  s_endpgm
m1_6220_3024:
  s_nop 7
  v_cndmask_b32 v212, v7, v164, s[64:65]
  v_cndmask_b32 v213, v7, v165, s[66:67]
  v_cndmask_b32 v214, v7, v166, s[68:69]
  v_cndmask_b32 v215, v7, v167, s[70:71]
  v_cndmask_b32 v216, v7, v168, s[72:73]
  v_cndmask_b32 v217, v7, v169, s[74:75]
  v_cndmask_b32 v218, v7, v170, s[76:77]
  v_cndmask_b32 v219, v7, v171, s[78:79]
  v_cndmask_b32 v220, v7, v172, s[80:81]
  v_cndmask_b32 v221, v7, v173, s[82:83]
  v_cndmask_b32 v222, v7, v174, s[84:85]
  v_cndmask_b32 v223, v7, v175, s[86:87]
  v_cndmask_b32 v224, v7, v176, s[88:89]
  v_cndmask_b32 v225, v7, v177, s[90:91]
  v_cndmask_b32 v226, v7, v178, s[92:93]
  v_cndmask_b32 v227, v7, v179, s[94:95]
  s_branch m2_6220_3025
x_6220_3026:
  s_waitcnt vmcnt(0)
  s_nop 1
  v_mfma_f32_32x32x16_bf16 v[196:211], v[136:139], v[224:227], v[196:211]
  v_mfma_f32_32x32x16_bf16 v[196:211], v[68:71], v[212:215], v[196:211]
  v_mfma_f32_32x32x16_bf16 v[196:211], v[72:75], v[216:219], v[196:211]
  s_branch p2_6220_3023
x_6220_3027:
  s_waitcnt vmcnt(0)
  s_nop 1
  v_mfma_f32_32x32x16_bf16 v[196:211], v[124:127], v[148:151], v[196:211]
  v_mfma_f32_32x32x16_bf16 v[196:211], v[128:131], v[152:155], v[196:211]
  s_branch p2_6220_3023
x_6220_3028:
  s_waitcnt vmcnt(0)
  s_nop 1
  v_mfma_f32_32x32x16_bf16 v[196:211], v[116:119], v[164:167], v[196:211]
  v_mfma_f32_32x32x16_bf16 v[196:211], v[120:123], v[168:171], v[196:211]
  s_branch p2_6220_3023
x_6220_3029:
  s_waitcnt vmcnt(0)
  s_nop 1
  v_mfma_f32_32x32x16_bf16 v[196:211], v[108:111], v[212:215], v[196:211]
  v_mfma_f32_32x32x16_bf16 v[196:211], v[112:115], v[216:219], v[196:211]
  s_branch p2_6220_3023
x_6220_3030:
  s_waitcnt vmcnt(0)
  s_nop 1
  v_mfma_f32_32x32x16_bf16 v[196:211], v[100:103], v[148:151], v[196:211]
  v_mfma_f32_32x32x16_bf16 v[196:211], v[104:107], v[152:155], v[196:211]
  s_branch p2_6220_3023
x_6220_3031:
  s_waitcnt vmcnt(0)
  s_nop 1
  v_mfma_f32_32x32x16_bf16 v[196:211], v[92:95], v[164:167], v[196:211]
  v_mfma_f32_32x32x16_bf16 v[196:211], v[96:99], v[168:171], v[196:211]
  s_branch p2_6220_3023
x_6220_3032:
  s_waitcnt vmcnt(0)
  s_nop 1
  v_mfma_f32_32x32x16_bf16 v[196:211], v[84:87], v[212:215], v[196:211]
  v_mfma_f32_32x32x16_bf16 v[196:211], v[88:91], v[216:219], v[196:211]
  s_branch p2_6220_3023
m1_6220_3035:
  s_nop 7
  v_cndmask_b32 v212, v7, v164, s[64:65]
  v_cndmask_b32 v213, v7, v165, s[66:67]
  v_cndmask_b32 v214, v7, v166, s[68:69]
  v_cndmask_b32 v215, v7, v167, s[70:71]
  v_cndmask_b32 v216, v7, v168, s[72:73]
  v_cndmask_b32 v217, v7, v169, s[74:75]
  v_cndmask_b32 v218, v7, v170, s[76:77]
  v_cndmask_b32 v219, v7, v171, s[78:79]
  v_cndmask_b32 v220, v7, v172, s[80:81]
  v_cndmask_b32 v221, v7, v173, s[82:83]
  v_cndmask_b32 v222, v7, v174, s[84:85]
  v_cndmask_b32 v223, v7, v175, s[86:87]
  v_cndmask_b32 v224, v7, v176, s[88:89]
  v_cndmask_b32 v225, v7, v177, s[90:91]
  v_cndmask_b32 v226, v7, v178, s[92:93]
  v_cndmask_b32 v227, v7, v179, s[94:95]
  s_branch m2_6220_3036
x_6220_3037:
  s_waitcnt vmcnt(0)
  s_nop 1
  v_mfma_f32_32x32x16_bf16 v[196:211], v[144:147], v[224:227], v[196:211]
  v_mfma_f32_32x32x16_bf16 v[196:211], v[76:79], v[212:215], v[196:211]
  v_mfma_f32_32x32x16_bf16 v[196:211], v[80:83], v[216:219], v[196:211]
  s_branch p2_6220_3034
x_6220_3038:
  s_waitcnt vmcnt(0)
  s_nop 1
  v_mfma_f32_32x32x16_bf16 v[196:211], v[132:135], v[148:151], v[196:211]
  v_mfma_f32_32x32x16_bf16 v[196:211], v[136:139], v[152:155], v[196:211]
  s_branch p2_6220_3034
x_6220_3039:
  s_waitcnt vmcnt(0)
  s_nop 1
  v_mfma_f32_32x32x16_bf16 v[196:211], v[124:127], v[164:167], v[196:211]
  v_mfma_f32_32x32x16_bf16 v[196:211], v[128:131], v[168:171], v[196:211]
  s_branch p2_6220_3034
x_6220_3040:
  s_waitcnt vmcnt(0)
  s_nop 1
  v_mfma_f32_32x32x16_bf16 v[196:211], v[116:119], v[212:215], v[196:211]
  v_mfma_f32_32x32x16_bf16 v[196:211], v[120:123], v[216:219], v[196:211]
  s_branch p2_6220_3034
x_6220_3041:
  s_waitcnt vmcnt(0)
  s_nop 1
  v_mfma_f32_32x32x16_bf16 v[196:211], v[108:111], v[148:151], v[196:211]
  v_mfma_f32_32x32x16_bf16 v[196:211], v[112:115], v[152:155], v[196:211]
  s_branch p2_6220_3034
x_6220_3042:
  s_waitcnt vmcnt(0)
  s_nop 1
  v_mfma_f32_32x32x16_bf16 v[196:211], v[100:103], v[164:167], v[196:211]
  v_mfma_f32_32x32x16_bf16 v[196:211], v[104:107], v[168:171], v[196:211]
  s_branch p2_6220_3034
x_6220_3043:
  s_waitcnt vmcnt(0)
  s_nop 1
  v_mfma_f32_32x32x16_bf16 v[196:211], v[92:95], v[212:215], v[196:211]
  v_mfma_f32_32x32x16_bf16 v[196:211], v[96:99], v[216:219], v[196:211]
  s_branch p2_6220_3034
L_END:
  s_endpgm
.section .rodata,"a"
.p2align 6
.amdhsa_kernel parallel_sum__sliding_block__glu_gated_reglu__prompt_kernel
  .amdhsa_next_free_vgpr 256
  .amdhsa_next_free_sgpr 100
  .amdhsa_accum_offset 256
  .amdhsa_group_segment_fixed_size 0
  .amdhsa_kernarg_size 80
  .amdhsa_user_sgpr_count 2
  .amdhsa_user_sgpr_kernarg_segment_ptr 1
  .amdhsa_system_sgpr_workgroup_id_x 1
.end_amdhsa_kernel
```
